```python
import torch

def _softmax(x, axis=-1):
    return torch.softmax(x, dim=axis)
def _gelu(x):
    return torch.nn.functional.gelu(x, approximate="tanh")
def _silu(x):
    return torch.nn.functional.silu(x)
def _sigmoid(x):
    return torch.sigmoid(x)
def _layernorm(x, axis=-1, eps=1e-5):
    m = x.mean(dim=axis, keepdim=True)
    v = x.var(dim=axis, keepdim=True, unbiased=False)
    return (x - m) / torch.sqrt(v + eps)
def _scatter_add(tgt, idx, src, axis=0):
    return tgt.clone().index_add_(axis, idx, src)
def _segment_sum(src, seg, n):
    out = torch.zeros((n,) + src.shape[1:], dtype=src.dtype)
    return out.index_add_(0, seg, src)
def _pad(x, pw):
    flat = tuple(v for pair in reversed(pw) for v in pair)
    return torch.nn.functional.pad(x, flat)

kernel_name = 'recurrent_scan__linear_attn_block__mixer_channel_mlp__prompt'

def setup_inputs():

    _w = (lambda a: (lambda t: t.to(torch.bfloat16) if t.is_floating_point() else t)(torch.as_tensor(a)))
    def _A_setup():
        B, S, D = 1, 2048, 640
        return {
            "x": _w((lambda *s: torch.randn(*s, dtype=torch.bfloat16) * 0.05)(B, S, D)),
            "wqkv": _w((lambda *s: torch.randn(*s, dtype=torch.bfloat16) * 0.2)(D, 3 * D)),
            "wo": _w((lambda *s: torch.randn(*s, dtype=torch.bfloat16) * 0.2)(D, D)),
        }
    _A_in = _A_setup()

    def _B_setup():
        B, S, D, F = 1, 2048, 640, 1536
        return {
            "x": _w((lambda *s: torch.randn(*s, dtype=torch.bfloat16) * 0.05)(B, S, D)),
            "w1": _w((lambda *s: torch.randn(*s, dtype=torch.bfloat16) * 0.8)(D, F) * (D ** -0.5)),
            "b1": _w((lambda *s: torch.randn(*s, dtype=torch.bfloat16) * 0.8)(F)),
            "w2": _w((lambda *s: torch.randn(*s, dtype=torch.bfloat16) * 0.1)(F, D) * (F ** -0.5)),
            "b2": _w((lambda *s: torch.randn(*s, dtype=torch.bfloat16) * 0.1)(D)),
        }
    _B_in = _B_setup()

    return {
        "A_x": _A_in["x"],
        "A_wqkv": _A_in["wqkv"],
        "A_wo": _A_in["wo"],
        "B_x": _B_in["x"],
        "B_w1": _B_in["w1"],
        "B_b1": _B_in["b1"],
        "B_w2": _B_in["w2"],
        "B_b2": _B_in["b2"],
    }

def reference(A_x, A_wqkv, A_wo, B_x, B_w1, B_b1, B_w2, B_b2):
    def _A_ref(x, wqkv, wo):
        B, S, D = x.shape
        H = 32; Dh = D // H
        qkv = (lambda x, *d: x.permute(*d))((x @ wqkv).reshape(B, S, 3, H, Dh), 2, 0, 3, 1, 4)
        q, k, v = qkv[0], qkv[1], qkv[2]
        phi = lambda t: torch.where(t > 0, t + 1, torch.exp(t)) + 1e-6
        pq, pk = phi(q), phi(k)
        kv = torch.einsum("bhsd,bhse->bhde", pk, v)
        z = torch.einsum("bhsd->bhd", pk)
        num = torch.einsum("bhqd,bhde->bhqe", pq, kv)
        den = torch.einsum("bhqd,bhd->bhq", pq, z)[..., None] + 1e-6
        o = num / den
        return (lambda x, *d: x.permute(*d))(o, 0, 2, 1, 3).reshape(B, S, D) @ wo

    def _B_ref(x, w1, b1, w2, b2):
        y = _layernorm(x, axis=-1)
        h = _gelu(torch.einsum("bsd,df->bsf", y, w1) + b1)
        return torch.einsum("bsf,fd->bsd", h, w2) + b2

    x = A_x
    xn = _layernorm(x, axis=-1)
    s = _A_ref(xn, A_wqkv, A_wo)
    g = _silu(_B_ref(xn, B_w1, B_b1, B_w2, B_b2))
    return x + s * g
```

```asm
; @launch grid=(256,1,1) block=(512,1,1) lds=163840
.amdgcn_target "amdgcn-amd-amdhsa--gfx950"
.text
.globl recurrent_scan__linear_attn_block__mixer_channel_mlp__prompt_kernel
.p2align 8
.type recurrent_scan__linear_attn_block__mixer_channel_mlp__prompt_kernel,@function
recurrent_scan__linear_attn_block__mixer_channel_mlp__prompt_kernel:
    s_cmp_ge_u32 s2, 256
    s_cbranch_scc1 Lend
    s_load_dwordx16 s[4:19], s[0:1], 0
    s_load_dwordx4 s[20:23], s[0:1], 64
    s_load_dwordx2 s[24:25], s[0:1], 80
    v_lshrrev_b32 v2, 6, v0
    v_and_b32 v1, 63, v0
    v_readfirstlane_b32 s60, v2
    s_and_b32 s66, s2, 7
    s_lshr_b32 s67, s2, 3
    s_bfe_u32 s70, s66, 0x10000
    s_lshl_b32 s70, s70, 3
    s_bfe_u32 s71, s67, 0x30000
    s_add_u32 s61, s70, s71
    s_bfe_u32 s70, s66, 0x20001
    s_lshl_b32 s70, s70, 1
    s_bfe_u32 s71, s67, 0x10003
    s_add_u32 s62, s70, s71
    s_bfe_u32 s63, s67, 0x10004
    s_lshl_b32 s27, s62, 1
    s_add_u32 s27, s27, s63
    s_mul_i32 s26, s61, 7
    s_mul_i32 s70, s27, 1
    s_add_u32 s26, s26, s70
    s_mul_i32 s70, s26, 6554
    s_lshr_b32 s70, s70, 16
    s_mul_i32 s70, s70, 10
    s_sub_u32 s26, s26, s70
    s_cmp_ge_u32 s60, 4
    s_cbranch_scc1 Lcompute
    s_mov_b32 s68, s60
    s_mov_b32 s74, s26
    v_lshrrev_b32 v2, 3, v1
    v_lshrrev_b32 v3, 4, v1
    v_and_b32 v4, 7, v1
    v_xor_b32 v5, v4, v3
    s_lshl_b32 s70, s61, 2
    s_add_u32 s70, s70, s68
    s_mul_i32 s70, s70, 40960
    v_mul_u32_u24 v6, 1280, v2
    v_lshl_add_u32 v6, v5, 4, v6
    v_add_u32 v12, s70, v6
    v_xor_b32 v7, 64, v12
    v_add_u32 v13, 10240, v7
    v_add_u32 v14, 20480, v12
    v_add_u32 v15, 30720, v7
    s_lshl_b32 s86, s68, 12
    s_add_u32 s87, s86, 1024
    s_add_u32 s88, s86, 2048
    s_add_u32 s89, s86, 3072
    s_lshl_b32 s75, s74, 7
    s_waitcnt lgkmcnt(0)
    s_mov_b32 s28, s4
    s_and_b32 s29, s5, 0xffff
    s_mov_b32 s30, 0x280000
    s_mov_b32 s31, 0x20000
    s_add_u32 m0, s86, 0
    s_nop 0
    buffer_load_dwordx4 v12, s[28:31], s75 offen lds
    s_add_u32 m0, s87, 0
    s_nop 0
    buffer_load_dwordx4 v13, s[28:31], s75 offen lds
    s_add_u32 m0, s88, 0
    s_nop 0
    buffer_load_dwordx4 v14, s[28:31], s75 offen lds
    s_add_u32 m0, s89, 0
    s_nop 0
    buffer_load_dwordx4 v15, s[28:31], s75 offen lds
    s_mov_b32 s32, s6
    s_and_b32 s33, s7, 0xffff
    s_mov_b32 s34, 0x258000
    s_mov_b32 s35, 0x20000
    s_mov_b32 s36, s12
    s_and_b32 s37, s13, 0xffff
    s_mov_b32 s38, 0x1e0000
    s_mov_b32 s39, 0x20000
    s_mul_i32 s76, s74, 245760
    s_mul_i32 s78, s74, 196608
    s_mul_i32 s73, s62, 384
    s_cmp_lg_u32 s63, 0
    s_cbranch_scc1 Lld_setq
    s_mov_b32 s40, s32
    s_mov_b32 s41, s33
    s_mov_b32 s42, s34
    s_mov_b32 s43, 0x20000
    s_mov_b32 s77, s76
    v_lshrrev_b32 v6, 1, v4
    v_xor_b32 v6, v6, v3
    v_and_b32 v7, 1, v4
    v_lshl_add_u32 v6, v6, 1, v7
    v_and_b32 v7, 4, v2
    v_add_u32 v7, v7, v2
    v_mul_u32_u24 v7, 3072, v7
    v_lshl_add_u32 v6, v6, 4, v7
    s_mul_i32 s70, s68, 49152
    s_add_u32 s70, s70, s73
    v_add_u32 v21, s70, v6
    v_add_u32 v22, 12288, v21
    s_lshl_b32 s70, s68, 11
    s_add_u32 s95, s70, 36864
    s_add_u32 s96, s70, 37888
    s_add_u32 m0, s95, 0
    s_nop 0
    buffer_load_dwordx4 v21, s[36:39], s78 offen lds
    s_add_u32 m0, s96, 0
    s_nop 0
    buffer_load_dwordx4 v22, s[36:39], s78 offen lds
    s_and_b32 s71, s68, 1
    s_mul_i32 s71, s71, 320
    s_lshr_b32 s72, s68, 1
    s_mul_i32 s72, s72, 1280
    s_mul_i32 s70, s62, 160
    s_add_u32 s72, s72, s70
    s_add_u32 s72, s72, 1280
    s_mul_i32 s70, s68, 5120
    s_add_u32 s90, s70, 16384
    v_add_u32 v6, s71, v1
    v_mul_u32_u24 v7, 6554, v6
    v_lshrrev_b32 v7, 16, v7
    v_mad_i32_i24 v8, v7, -10, v6
    v_lshrrev_b32 v9, 1, v7
    v_xor_b32 v9, v9, v7
    v_and_b32 v9, 4, v9
    v_mul_u32_u24 v9, 3, v9
    v_xor_b32 v7, v7, v9
    v_mul_u32_u24 v7, 3840, v7
    v_lshl_add_u32 v7, v8, 4, v7
    v_add_u32 v16, s72, v7
    s_add_u32 m0, s90, 0
    s_nop 0
    buffer_load_dwordx4 v16, s[32:35], s76 offen lds
    s_add_u32 s91, s70, 17408
    v_add_u32 v6, s71, v1
    v_add_u32 v6, 64, v6
    v_mul_u32_u24 v7, 6554, v6
    v_lshrrev_b32 v7, 16, v7
    v_mad_i32_i24 v8, v7, -10, v6
    v_lshrrev_b32 v9, 1, v7
    v_xor_b32 v9, v9, v7
    v_and_b32 v9, 4, v9
    v_mul_u32_u24 v9, 3, v9
    v_xor_b32 v7, v7, v9
    v_mul_u32_u24 v7, 3840, v7
    v_lshl_add_u32 v7, v8, 4, v7
    v_add_u32 v17, s72, v7
    s_add_u32 m0, s91, 0
    s_nop 0
    buffer_load_dwordx4 v17, s[32:35], s76 offen lds
    s_add_u32 s92, s70, 18432
    v_add_u32 v6, s71, v1
    v_add_u32 v6, 128, v6
    v_mul_u32_u24 v7, 6554, v6
    v_lshrrev_b32 v7, 16, v7
    v_mad_i32_i24 v8, v7, -10, v6
    v_lshrrev_b32 v9, 1, v7
    v_xor_b32 v9, v9, v7
    v_and_b32 v9, 4, v9
    v_mul_u32_u24 v9, 3, v9
    v_xor_b32 v7, v7, v9
    v_mul_u32_u24 v7, 3840, v7
    v_lshl_add_u32 v7, v8, 4, v7
    v_add_u32 v18, s72, v7
    s_add_u32 m0, s92, 0
    s_nop 0
    buffer_load_dwordx4 v18, s[32:35], s76 offen lds
    s_add_u32 s93, s70, 19456
    v_add_u32 v6, s71, v1
    v_add_u32 v6, 192, v6
    v_mul_u32_u24 v7, 6554, v6
    v_lshrrev_b32 v7, 16, v7
    v_mad_i32_i24 v8, v7, -10, v6
    v_lshrrev_b32 v9, 1, v7
    v_xor_b32 v9, v9, v7
    v_and_b32 v9, 4, v9
    v_mul_u32_u24 v9, 3, v9
    v_xor_b32 v7, v7, v9
    v_mul_u32_u24 v7, 3840, v7
    v_lshl_add_u32 v7, v8, 4, v7
    v_add_u32 v19, s72, v7
    s_add_u32 m0, s93, 0
    s_nop 0
    buffer_load_dwordx4 v19, s[40:43], s77 offen lds
    s_add_u32 s94, s70, 20480
    v_add_u32 v6, s71, v1
    v_add_u32 v6, 256, v6
    v_mul_u32_u24 v7, 6554, v6
    v_lshrrev_b32 v7, 16, v7
    v_mad_i32_i24 v8, v7, -10, v6
    v_lshrrev_b32 v9, 1, v7
    v_xor_b32 v9, v9, v7
    v_and_b32 v9, 4, v9
    v_mul_u32_u24 v9, 3, v9
    v_xor_b32 v7, v7, v9
    v_mul_u32_u24 v7, 3840, v7
    v_lshl_add_u32 v7, v8, 4, v7
    v_add_u32 v20, s72, v7
    s_add_u32 m0, s94, 0
    s_nop 0
    buffer_load_dwordx4 v20, s[40:43], s77 offen lds
    s_branch Lld_setdone
Lld_setq:
    s_mov_b32 s40, s36
    s_mov_b32 s41, s37
    s_mov_b32 s42, s38
    s_mov_b32 s43, 0x20000
    s_mov_b32 s77, s78
    s_add_u32 s73, s73, 128
    v_and_b32 v8, 15, v1
    v_lshrrev_b32 v6, 1, v8
    v_xor_b32 v6, v6, v3
    v_and_b32 v7, 1, v8
    v_lshl_add_u32 v6, v6, 1, v7
    v_mul_u32_u24 v7, 3072, v3
    v_lshl_add_u32 v6, v6, 4, v7
    v_xor_b32 v7, 128, v6
    s_mul_i32 s70, s68, 49152
    s_add_u32 s70, s70, s73
    v_add_u32 v19, s70, v6
    v_add_u32 v7, s70, v7
    v_add_u32 v20, 24576, v7
    v_add_u32 v21, 12288, v19
    v_add_u32 v22, 36864, v7
    s_lshl_b32 s70, s68, 12
    s_add_u32 s93, s70, 26624
    s_add_u32 m0, s93, 0
    s_nop 0
    buffer_load_dwordx4 v19, s[40:43], s77 offen lds
    s_add_u32 s94, s70, 27648
    s_add_u32 m0, s94, 0
    s_nop 0
    buffer_load_dwordx4 v20, s[40:43], s77 offen lds
    s_add_u32 s95, s70, 28672
    s_add_u32 m0, s95, 0
    s_nop 0
    buffer_load_dwordx4 v21, s[36:39], s78 offen lds
    s_add_u32 s96, s70, 29696
    s_add_u32 m0, s96, 0
    s_nop 0
    buffer_load_dwordx4 v22, s[36:39], s78 offen lds
    s_mul_i32 s71, s68, 192
    s_mul_i32 s72, s62, 160
    s_mul_i32 s70, s68, 3072
    s_add_u32 s90, s70, 16384
    v_add_u32 v6, s71, v1
    v_mul_u32_u24 v7, 6554, v6
    v_lshrrev_b32 v7, 16, v7
    v_mad_i32_i24 v8, v7, -10, v6
    v_lshrrev_b32 v9, 1, v7
    v_xor_b32 v9, v9, v7
    v_and_b32 v9, 4, v9
    v_mul_u32_u24 v9, 3, v9
    v_xor_b32 v7, v7, v9
    v_mul_u32_u24 v7, 3840, v7
    v_lshl_add_u32 v7, v8, 4, v7
    v_add_u32 v16, s72, v7
    s_add_u32 m0, s90, 0
    s_nop 0
    buffer_load_dwordx4 v16, s[32:35], s76 offen lds
    s_add_u32 s91, s70, 17408
    s_cmp_eq_u32 s68, 3
    s_cselect_b32 s91, 43008, s91
    v_add_u32 v6, s71, v1
    v_add_u32 v6, 64, v6
    v_mul_u32_u24 v7, 6554, v6
    v_lshrrev_b32 v7, 16, v7
    v_mad_i32_i24 v8, v7, -10, v6
    v_lshrrev_b32 v9, 1, v7
    v_xor_b32 v9, v9, v7
    v_and_b32 v9, 4, v9
    v_mul_u32_u24 v9, 3, v9
    v_xor_b32 v7, v7, v9
    v_mul_u32_u24 v7, 3840, v7
    v_lshl_add_u32 v7, v8, 4, v7
    v_add_u32 v17, s72, v7
    v_cmp_gt_u32 vcc, 640, v6
    v_mov_b32 v9, 0x40000000
    s_nop 0
    v_cndmask_b32 v17, v9, v17, vcc
    s_add_u32 m0, s91, 0
    s_nop 0
    buffer_load_dwordx4 v17, s[32:35], s76 offen lds
    s_add_u32 s92, s70, 18432
    s_cmp_eq_u32 s68, 3
    s_cselect_b32 s92, 44032, s92
    v_add_u32 v6, s71, v1
    v_add_u32 v6, 128, v6
    v_mul_u32_u24 v7, 6554, v6
    v_lshrrev_b32 v7, 16, v7
    v_mad_i32_i24 v8, v7, -10, v6
    v_lshrrev_b32 v9, 1, v7
    v_xor_b32 v9, v9, v7
    v_and_b32 v9, 4, v9
    v_mul_u32_u24 v9, 3, v9
    v_xor_b32 v7, v7, v9
    v_mul_u32_u24 v7, 3840, v7
    v_lshl_add_u32 v7, v8, 4, v7
    v_add_u32 v18, s72, v7
    v_cmp_gt_u32 vcc, 640, v6
    v_mov_b32 v9, 0x40000000
    s_nop 0
    v_cndmask_b32 v18, v9, v18, vcc
    s_add_u32 m0, s92, 0
    s_nop 0
    buffer_load_dwordx4 v18, s[32:35], s76 offen lds
Lld_setdone:
    s_add_u32 s74, s74, 1
    s_cmp_eq_u32 s74, 10
    s_cselect_b32 s74, 0, s74
    s_lshl_b32 s75, s74, 7
    s_mul_i32 s76, s74, 245760
    s_mul_i32 s78, s74, 196608
    s_cmp_lg_u32 s63, 0
    s_cselect_b32 s77, s78, s76
    s_add_u32 m0, s86, 45056
    s_nop 0
    buffer_load_dwordx4 v12, s[28:31], s75 offen lds
    s_add_u32 m0, s87, 45056
    s_nop 0
    buffer_load_dwordx4 v13, s[28:31], s75 offen lds
    s_add_u32 m0, s88, 45056
    s_nop 0
    buffer_load_dwordx4 v14, s[28:31], s75 offen lds
    s_add_u32 m0, s89, 45056
    s_nop 0
    buffer_load_dwordx4 v15, s[28:31], s75 offen lds
    s_add_u32 m0, s90, 45056
    s_nop 0
    buffer_load_dwordx4 v16, s[32:35], s76 offen lds
    s_mov_b32 s44, s24
    s_and_b32 s45, s25, 0xffff
    s_mov_b32 s46, 0xf00000
    s_mov_b32 s47, 0x20000
    s_lshr_b32 s70, s66, 1
    s_lshl_b32 s70, s70, 3
    s_and_b32 s71, s67, 7
    s_add_u32 s64, s70, s71
    s_and_b32 s70, s66, 1
    s_lshl_b32 s70, s70, 2
    s_lshr_b32 s71, s67, 3
    s_add_u32 s65, s70, s71
    s_add_u32 s81, s62, 128
    s_cmp_lt_u32 s61, 4
    s_cselect_b32 s81, s81, 255
    s_lshl_b32 s70, s62, 4
    s_add_u32 s70, s70, s61
    s_cmp_eq_u32 s63, 1
    s_cselect_b32 s81, s70, s81
    v_mov_b32 v42, 0
    v_mov_b32 v40, 0
    s_or_b32 s70, s68, s2
    s_cbranch_scc1 Lnc_1
    s_load_dword s70, s[24:25], 0
    s_waitcnt lgkmcnt(0)
    s_mul_i32 s70, s70, 0x9E3779B1
    s_add_u32 s70, s70, 0x7F4A7C15
    s_cmp_eq_u32 s70, 0
    s_cselect_b32 s70, 1, s70
    v_mov_b32 v43, s70
    global_store_dword v42, v43, s[22:23] sc1
    global_store_dword v42, v43, s[24:25] sc1
Lnc_1:
    v_add_u32 v0, 256, v0
    v_lshlrev_b32 v39, 4, v1
    v_lshl_add_u32 v10, v1, 2, s73
    s_mov_b32 s56, s14
    s_and_b32 s57, s15, 0xffff
    s_mov_b32 s58, 0xc00
    s_mov_b32 s59, 0x20000
    v_mov_b32 v6, 0x40000000
    v_cmp_eq_u32 vcc, 0, v1
    v_cmp_gt_u32 s[84:85], 32, v1
    s_lshl_b32 s70, s61, 12
    s_lshl_b32 s71, s62, 7
    s_add_u32 s70, s70, s71
    s_lshl_b32 s71, s63, 10
    s_add_u32 s71, s71, s70
    s_add_u32 s71, s71, 1441792
    v_lshl_add_u32 v7, v1, 2, s71
    v_cndmask_b32 v24, v6, v7, s[84:85]
    s_add_u32 s73, s70, 1507328
    s_cmp_lg_u32 s63, 0
    s_cselect_b32 s73, s73, 0x40000000
    v_lshl_add_u32 v7, v1, 2, s73
    v_cndmask_b32 v25, v6, v7, s[84:85]
    s_lshl_b32 s70, s61, 7
    s_and_b32 s71, s81, 1
    s_lshl_b32 s71, s71, 9
    s_lshr_b32 s72, s81, 1
    s_lshl_b32 s72, s72, 2
    s_add_u32 s71, s71, s72
    s_lshl_b32 s72, s61, 4
    s_cmp_eq_u32 s63, 1
    s_cselect_b32 s72, 0, s72
    s_add_u32 s71, s71, s72
    s_add_u32 s71, s71, 9216
    v_mov_b32 v7, s71
    v_cndmask_b32 v26, v6, v7, vcc
    s_add_u32 s70, s70, 10240
    s_lshl_b32 s71, s27, 7
    s_add_u32 s71, s71, 12288
    s_lshl_b32 s72, s26, 2
    s_add_u32 s73, s70, s72
    s_cmp_lt_u32 s27, 10
    s_cselect_b32 s73, s73, 0x40000000
    v_mov_b32 v7, s73
    v_cndmask_b32 v27, v6, v7, vcc
    s_add_u32 s73, s71, s72
    s_cmp_lt_u32 s61, 10
    s_cselect_b32 s73, s73, 0x40000000
    v_writelane_b32 v27, s73, 1
    s_sub_u32 s71, s71, 40
    v_lshl_add_u32 v7, v1, 2, s70
    v_lshl_add_u32 v8, v1, 2, s71
    v_cmp_gt_u32 vcc, 10, v1
    s_nop 1
    v_cndmask_b32 v32, v8, v7, vcc
    s_lshr_b32 s71, s65, 2
    s_lshl_b32 s71, s71, 9
    s_add_u32 s71, s71, 9216
    v_lshl_add_u32 v29, v1, 3, s71
    s_and_b32 s71, s65, 3
    s_lshl_b32 s71, s71, 4
    v_add_u32 v7, s71, v29
    v_cndmask_b32 v29, v7, v29, s[84:85]
    s_lshr_b32 s71, s64, 1
    s_lshl_b32 s71, s71, 12
    s_add_u32 s71, s71, 1441792
    v_min_u32 v9, 7, v1
    v_lshl_add_u32 v28, v9, 7, s71
    v_add_u32 v30, 1024, v28
    v_add_u32 v33, 2048, v28
    s_add_u32 s71, s71, 65536
    v_lshl_add_u32 v31, v9, 7, s71
    v_and_b32 v6, 15, v1
    s_lshl_b32 s70, s68, 5
    v_add_u32 v6, s70, v6
    v_mul_u32_u24 v6, 168, v6
    v_lshl_add_u32 v6, v3, 3, v6
    v_add_u32 v38, 135168, v6
    s_lshl_b32 s70, s61, 3
    s_lshl_b32 s71, s68, 1
    s_add_u32 s70, s70, s71
    s_lshl_b32 s70, s70, 3
    s_add_u32 s70, s70, s62
    s_mul_i32 s70, s70, 2560
    s_add_u32 s101, s70, 5242880
    v_mov_b32 v8, 0x40000000
    v_mov_b32 v9, 0x40000000
    s_cmp_lg_u32 s63, 0
    s_cbranch_scc1 Lsq_2
    v_mov_b32 v5, 0x40000000
    v_and_b32 v4, 31, v1
    s_lshl_b32 s70, s61, 5
    v_add_u32 v4, s70, v4
    v_cmp_gt_u32 vcc, 420, v4
    v_lshlrev_b32 v4, 4, v4
    v_lshrrev_b32 v3, 5, v1
    v_mul_u32_u24 v3, 54272, v3
    v_add_u32 v3, v3, v4
    v_cndmask_b32 v3, v5, v3, vcc
    s_mov_b64 s[8:9], vcc
    v_cmp_gt_u32 vcc, 32, v1
    s_nop 1
    s_and_b64 vcc, vcc, s[8:9]
    v_cndmask_b32 v4, v5, v4, vcc
    s_branch Lse_3
Lsq_2:
    v_add_u32 v70, 4294967040, v0
    v_cmp_le_u32 vcc, 210, v70
    s_nop 1
    v_cndmask_b32 v84, 0, 1, vcc
    v_mov_b32 v86, -210
    v_mad_i32_i24 v85, v84, v86, v70
    v_mul_u32_u24 v86, 3121, v85
    v_lshrrev_b32 v86, 16, v86
    v_mov_b32 v88, -21
    v_mad_i32_i24 v87, v86, v88, v85
    v_cmp_le_u32 vcc, 5, v86
    s_nop 1
    v_cndmask_b32 v88, 0, 1, vcc
    v_lshlrev_b32 v89, 1, v88
    v_subrev_u32 v90, 16, v87
    v_lshlrev_b32 v90, 2, v90
    v_mad_u32_u24 v90, v88, 3, v90
    v_add_u32 v91, 1, v88
    v_cmp_eq_u32 s[84:85], 20, v87
    s_nop 1
    v_cndmask_b32 v90, v90, v91, s[84:85]
    v_cmp_gt_u32 vcc, 16, v87
    s_nop 1
    v_cndmask_b32 v90, v90, v87, vcc
    v_cndmask_b32 v89, 1, v89, vcc
    v_and_b32 v91, 3, v86
    v_lshl_add_u32 v90, v91, 4, v90
    v_lshlrev_b32 v91, 10, v89
    v_lshl_add_u32 v91, v90, 4, v91
    v_and_b32 v92, 4, v86
    v_lshl_add_u32 v91, v92, 1, v91
    v_lshrrev_b32 v92, 1, v89
    v_lshlrev_b32 v92, 9, v92
    v_lshl_add_u32 v92, v90, 3, v92
    v_add_u32 v92, 3072, v92
    v_cmp_le_u32 vcc, 8, v86
    s_nop 1
    v_cndmask_b32 v91, v91, v92, vcc
    v_cndmask_b32 v36, 64, 32, vcc
    v_mul_u32_u24 v84, 90112, v84
    v_add_u32 v91, v84, v91
    v_add_u32 v34, 40960, v91
    v_mov_b32 v86, 0x40000000
    v_cmp_gt_u32 vcc, 420, v70
    v_lshlrev_b32 v70, 4, v70
    s_nop 0
    v_cndmask_b32 v8, v86, v70, vcc
    s_and_b64 s[10:11], s[84:85], vcc
    v_add_u32 v70, 0, v0
    v_cmp_le_u32 vcc, 210, v70
    s_nop 1
    v_cndmask_b32 v84, 0, 1, vcc
    v_mov_b32 v86, -210
    v_mad_i32_i24 v85, v84, v86, v70
    v_mul_u32_u24 v86, 3121, v85
    v_lshrrev_b32 v86, 16, v86
    v_mov_b32 v88, -21
    v_mad_i32_i24 v87, v86, v88, v85
    v_cmp_le_u32 vcc, 5, v86
    s_nop 1
    v_cndmask_b32 v88, 0, 1, vcc
    v_lshlrev_b32 v89, 1, v88
    v_subrev_u32 v90, 16, v87
    v_lshlrev_b32 v90, 2, v90
    v_mad_u32_u24 v90, v88, 3, v90
    v_add_u32 v91, 1, v88
    v_cmp_eq_u32 s[84:85], 20, v87
    s_nop 1
    v_cndmask_b32 v90, v90, v91, s[84:85]
    v_cmp_gt_u32 vcc, 16, v87
    s_nop 1
    v_cndmask_b32 v90, v90, v87, vcc
    v_cndmask_b32 v89, 1, v89, vcc
    v_and_b32 v91, 3, v86
    v_lshl_add_u32 v90, v91, 4, v90
    v_lshlrev_b32 v91, 10, v89
    v_lshl_add_u32 v91, v90, 4, v91
    v_and_b32 v92, 4, v86
    v_lshl_add_u32 v91, v92, 1, v91
    v_lshrrev_b32 v92, 1, v89
    v_lshlrev_b32 v92, 9, v92
    v_lshl_add_u32 v92, v90, 3, v92
    v_add_u32 v92, 3072, v92
    v_cmp_le_u32 vcc, 8, v86
    s_nop 1
    v_cndmask_b32 v91, v91, v92, vcc
    v_cndmask_b32 v37, 64, 32, vcc
    v_mul_u32_u24 v84, 90112, v84
    v_add_u32 v91, v84, v91
    v_add_u32 v35, 40960, v91
    v_mov_b32 v86, 0x40000000
    v_cmp_gt_u32 vcc, 420, v70
    v_lshlrev_b32 v70, 4, v70
    s_nop 0
    v_cndmask_b32 v9, v86, v70, vcc
    s_and_b64 s[16:17], s[84:85], vcc
    s_mov_b64 s[8:9], vcc
    s_mul_i32 s70, s62, 6784
    s_add_u32 s100, s70, 1572864
Lse_3:
    s_waitcnt vmcnt(5)
    s_barrier
    s_add_u32 m0, s91, 45056
    s_nop 0
    buffer_load_dwordx4 v17, s[32:35], s76 offen lds
    s_add_u32 m0, s92, 45056
    s_nop 0
    buffer_load_dwordx4 v18, s[32:35], s76 offen lds
    s_add_u32 m0, s93, 45056
    s_nop 0
    buffer_load_dwordx4 v19, s[40:43], s77 offen lds
    s_add_u32 m0, s94, 45056
    s_nop 0
    buffer_load_dwordx4 v20, s[40:43], s77 offen lds
    s_add_u32 m0, s95, 45056
    s_nop 0
    buffer_load_dwordx4 v21, s[36:39], s78 offen lds
    s_add_u32 m0, s96, 45056
    s_nop 0
    buffer_load_dwordx4 v22, s[36:39], s78 offen lds
    s_cmp_lg_u32 s68, 1
    s_cbranch_scc1 Ll0_4
    s_mov_b32 m0, 163328
    s_nop 0
    buffer_load_dword v10, s[56:59], 0 offen lds
Ll0_4:
    s_add_u32 s74, s74, 1
    s_cmp_eq_u32 s74, 10
    s_cselect_b32 s74, 0, s74
    s_lshl_b32 s75, s74, 7
    s_mul_i32 s76, s74, 245760
    s_mul_i32 s78, s74, 196608
    s_cmp_lg_u32 s63, 0
    s_cselect_b32 s77, s78, s76
    s_add_u32 m0, s86, 90112
    s_nop 0
    buffer_load_dwordx4 v12, s[28:31], s75 offen lds
    s_add_u32 m0, s87, 90112
    s_nop 0
    buffer_load_dwordx4 v13, s[28:31], s75 offen lds
    s_add_u32 m0, s88, 90112
    s_nop 0
    buffer_load_dwordx4 v14, s[28:31], s75 offen lds
    s_add_u32 m0, s89, 90112
    s_nop 0
    buffer_load_dwordx4 v15, s[28:31], s75 offen lds
    s_add_u32 m0, s90, 90112
    s_nop 0
    buffer_load_dwordx4 v16, s[32:35], s76 offen lds
    s_add_u32 m0, s91, 90112
    s_nop 0
    buffer_load_dwordx4 v17, s[32:35], s76 offen lds
    s_add_u32 m0, s92, 90112
    s_nop 0
    buffer_load_dwordx4 v18, s[32:35], s76 offen lds
    s_add_u32 m0, s93, 90112
    s_nop 0
    buffer_load_dwordx4 v19, s[40:43], s77 offen lds
    s_add_u32 m0, s94, 90112
    s_nop 0
    buffer_load_dwordx4 v20, s[40:43], s77 offen lds
    s_add_u32 m0, s95, 90112
    s_nop 0
    buffer_load_dwordx4 v21, s[36:39], s78 offen lds
    s_add_u32 m0, s96, 90112
    s_nop 0
    buffer_load_dwordx4 v22, s[36:39], s78 offen lds
    s_waitcnt vmcnt(11)
    s_barrier
    s_cmp_lg_u32 s68, 0
    s_cbranch_scc1 Ll0_5
    buffer_store_dword v42, v24, s[44:47], 0 offen sc1
    buffer_store_dword v42, v25, s[44:47], 0 offen sc1
    s_cmp_eq_u32 s63, 0
    s_cbranch_scc1 Ll0_5
    buffer_store_dword v42, v24, s[44:47], 0 offen offset:1024 sc1
Ll0_5:
    s_add_u32 s74, s74, 1
    s_cmp_eq_u32 s74, 10
    s_cselect_b32 s74, 0, s74
    s_lshl_b32 s75, s74, 7
    s_mul_i32 s76, s74, 245760
    s_mul_i32 s78, s74, 196608
    s_cmp_lg_u32 s63, 0
    s_cselect_b32 s77, s78, s76
    s_add_u32 m0, s86, 0
    s_nop 0
    buffer_load_dwordx4 v12, s[28:31], s75 offen lds
    s_add_u32 m0, s87, 0
    s_nop 0
    buffer_load_dwordx4 v13, s[28:31], s75 offen lds
    s_add_u32 m0, s88, 0
    s_nop 0
    buffer_load_dwordx4 v14, s[28:31], s75 offen lds
    s_add_u32 m0, s89, 0
    s_nop 0
    buffer_load_dwordx4 v15, s[28:31], s75 offen lds
    s_add_u32 m0, s90, 0
    s_nop 0
    buffer_load_dwordx4 v16, s[32:35], s76 offen lds
    s_add_u32 m0, s91, 0
    s_nop 0
    buffer_load_dwordx4 v17, s[32:35], s76 offen lds
    s_add_u32 m0, s92, 0
    s_nop 0
    buffer_load_dwordx4 v18, s[32:35], s76 offen lds
    s_add_u32 m0, s93, 0
    s_nop 0
    buffer_load_dwordx4 v19, s[40:43], s77 offen lds
    s_add_u32 m0, s94, 0
    s_nop 0
    buffer_load_dwordx4 v20, s[40:43], s77 offen lds
    s_add_u32 m0, s95, 0
    s_nop 0
    buffer_load_dwordx4 v21, s[36:39], s78 offen lds
    s_add_u32 m0, s96, 0
    s_nop 0
    buffer_load_dwordx4 v22, s[36:39], s78 offen lds
    s_waitcnt vmcnt(11)
    s_barrier
    s_cmp_lg_u32 s68, 0
    s_cbranch_scc1 Ll0_6
    global_load_dword v40, v42, s[22:23] sc1
Ll0_6:
    s_add_u32 s74, s74, 1
    s_cmp_eq_u32 s74, 10
    s_cselect_b32 s74, 0, s74
    s_lshl_b32 s75, s74, 7
    s_mul_i32 s76, s74, 245760
    s_mul_i32 s78, s74, 196608
    s_cmp_lg_u32 s63, 0
    s_cselect_b32 s77, s78, s76
    s_add_u32 m0, s86, 45056
    s_nop 0
    buffer_load_dwordx4 v12, s[28:31], s75 offen lds
    s_add_u32 m0, s87, 45056
    s_nop 0
    buffer_load_dwordx4 v13, s[28:31], s75 offen lds
    s_add_u32 m0, s88, 45056
    s_nop 0
    buffer_load_dwordx4 v14, s[28:31], s75 offen lds
    s_add_u32 m0, s89, 45056
    s_nop 0
    buffer_load_dwordx4 v15, s[28:31], s75 offen lds
    s_add_u32 m0, s90, 45056
    s_nop 0
    buffer_load_dwordx4 v16, s[32:35], s76 offen lds
    s_add_u32 m0, s91, 45056
    s_nop 0
    buffer_load_dwordx4 v17, s[32:35], s76 offen lds
    s_add_u32 m0, s92, 45056
    s_nop 0
    buffer_load_dwordx4 v18, s[32:35], s76 offen lds
    s_add_u32 m0, s93, 45056
    s_nop 0
    buffer_load_dwordx4 v19, s[40:43], s77 offen lds
    s_add_u32 m0, s94, 45056
    s_nop 0
    buffer_load_dwordx4 v20, s[40:43], s77 offen lds
    s_add_u32 m0, s95, 45056
    s_nop 0
    buffer_load_dwordx4 v21, s[36:39], s78 offen lds
    s_add_u32 m0, s96, 45056
    s_nop 0
    buffer_load_dwordx4 v22, s[36:39], s78 offen lds
    s_waitcnt vmcnt(11)
    s_cmp_lg_u32 s68, 0
    s_cbranch_scc1 Ll0_7
    v_readfirstlane_b32 s79, v40
    s_mov_b32 s80, 0
Lnp_8:
    s_nop 0
    s_cmp_lg_u32 s79, 0
    s_cbranch_scc1 Lnq_9
    s_add_u32 s80, s80, 1
    s_cmp_gt_u32 s80, 0x40000
    s_cbranch_scc1 Lnq_9
    global_load_dword v40, v42, s[22:23] sc1
    s_waitcnt vmcnt(0)
    v_readfirstlane_b32 s79, v40
    s_nop 1
    s_branch Lnp_8
Lnq_9:
    v_mov_b32 v41, s79
Ll0_7:
    s_barrier
    s_cmp_lg_u32 s60, 3
    s_cbranch_scc1 Lcp_10
    s_getpc_b64 s[70:71]
Lpc_11:
    s_sub_u32 s70, s70, Lpc_11-recurrent_scan__linear_attn_block__mixer_channel_mlp__prompt_kernel
    s_subb_u32 s71, s71, 0
    s_mul_i32 s72, s67, 1280
    v_lshlrev_b32 v160, 7, v1
    v_add_u32 v160, s72, v160
    v_min_u32 v160, Lcode_end-4-recurrent_scan__linear_attn_block__mixer_channel_mlp__prompt_kernel, v160
    v_mov_b32 v161, s71
    v_add_co_u32 v160, vcc, s70, v160
    s_nop 1
    v_addc_co_u32 v161, vcc, 0, v161, vcc
    s_mov_b32 exec_lo, 0x3ff
    s_mov_b32 exec_hi, 0x0
    global_load_dword v255, v[160:161], off
    s_mov_b64 exec, -1
Lcp_10:
    s_cmp_lg_u32 s68, 0
    s_cbranch_scc1 Ll0_12
    buffer_store_dword v41, v27, s[44:47], 0 offen sc1
Ll0_12:
    s_add_u32 s74, s74, 1
    s_cmp_eq_u32 s74, 10
    s_cselect_b32 s74, 0, s74
    s_lshl_b32 s75, s74, 7
    s_mul_i32 s76, s74, 245760
    s_mul_i32 s78, s74, 196608
    s_cmp_lg_u32 s63, 0
    s_cselect_b32 s77, s78, s76
    s_add_u32 m0, s86, 90112
    s_nop 0
    buffer_load_dwordx4 v12, s[28:31], s75 offen lds
    s_add_u32 m0, s87, 90112
    s_nop 0
    buffer_load_dwordx4 v13, s[28:31], s75 offen lds
    s_add_u32 m0, s88, 90112
    s_nop 0
    buffer_load_dwordx4 v14, s[28:31], s75 offen lds
    s_add_u32 m0, s89, 90112
    s_nop 0
    buffer_load_dwordx4 v15, s[28:31], s75 offen lds
    s_add_u32 m0, s90, 90112
    s_nop 0
    buffer_load_dwordx4 v16, s[32:35], s76 offen lds
    s_add_u32 m0, s91, 90112
    s_nop 0
    buffer_load_dwordx4 v17, s[32:35], s76 offen lds
    s_add_u32 m0, s92, 90112
    s_nop 0
    buffer_load_dwordx4 v18, s[32:35], s76 offen lds
    s_add_u32 m0, s93, 90112
    s_nop 0
    buffer_load_dwordx4 v19, s[40:43], s77 offen lds
    s_add_u32 m0, s94, 90112
    s_nop 0
    buffer_load_dwordx4 v20, s[40:43], s77 offen lds
    s_add_u32 m0, s95, 90112
    s_nop 0
    buffer_load_dwordx4 v21, s[36:39], s78 offen lds
    s_add_u32 m0, s96, 90112
    s_nop 0
    buffer_load_dwordx4 v22, s[36:39], s78 offen lds
    s_waitcnt vmcnt(11)
    s_barrier
    s_add_u32 s74, s74, 1
    s_cmp_eq_u32 s74, 10
    s_cselect_b32 s74, 0, s74
    s_lshl_b32 s75, s74, 7
    s_mul_i32 s76, s74, 245760
    s_mul_i32 s78, s74, 196608
    s_cmp_lg_u32 s63, 0
    s_cselect_b32 s77, s78, s76
    s_add_u32 m0, s86, 0
    s_nop 0
    buffer_load_dwordx4 v12, s[28:31], s75 offen lds
    s_add_u32 m0, s87, 0
    s_nop 0
    buffer_load_dwordx4 v13, s[28:31], s75 offen lds
    s_add_u32 m0, s88, 0
    s_nop 0
    buffer_load_dwordx4 v14, s[28:31], s75 offen lds
    s_add_u32 m0, s89, 0
    s_nop 0
    buffer_load_dwordx4 v15, s[28:31], s75 offen lds
    s_add_u32 m0, s90, 0
    s_nop 0
    buffer_load_dwordx4 v16, s[32:35], s76 offen lds
    s_add_u32 m0, s91, 0
    s_nop 0
    buffer_load_dwordx4 v17, s[32:35], s76 offen lds
    s_add_u32 m0, s92, 0
    s_nop 0
    buffer_load_dwordx4 v18, s[32:35], s76 offen lds
    s_add_u32 m0, s93, 0
    s_nop 0
    buffer_load_dwordx4 v19, s[40:43], s77 offen lds
    s_add_u32 m0, s94, 0
    s_nop 0
    buffer_load_dwordx4 v20, s[40:43], s77 offen lds
    s_add_u32 m0, s95, 0
    s_nop 0
    buffer_load_dwordx4 v21, s[36:39], s78 offen lds
    s_add_u32 m0, s96, 0
    s_nop 0
    buffer_load_dwordx4 v22, s[36:39], s78 offen lds
    s_waitcnt vmcnt(11)
    s_barrier
    s_cmp_gt_u32 s81, 135
    s_cbranch_scc1 Lpk_13
    s_cmp_lg_u32 s68, 0
    s_cbranch_scc1 Ll0_14
    buffer_store_dword v41, v26, s[44:47], 0 offen sc1
Ll0_14:
Lpk_13:
    s_add_u32 s74, s74, 1
    s_cmp_eq_u32 s74, 10
    s_cselect_b32 s74, 0, s74
    s_lshl_b32 s75, s74, 7
    s_mul_i32 s76, s74, 245760
    s_mul_i32 s78, s74, 196608
    s_cmp_lg_u32 s63, 0
    s_cselect_b32 s77, s78, s76
    s_add_u32 m0, s86, 45056
    s_nop 0
    buffer_load_dwordx4 v12, s[28:31], s75 offen lds
    s_add_u32 m0, s87, 45056
    s_nop 0
    buffer_load_dwordx4 v13, s[28:31], s75 offen lds
    s_add_u32 m0, s88, 45056
    s_nop 0
    buffer_load_dwordx4 v14, s[28:31], s75 offen lds
    s_add_u32 m0, s89, 45056
    s_nop 0
    buffer_load_dwordx4 v15, s[28:31], s75 offen lds
    s_add_u32 m0, s90, 45056
    s_nop 0
    buffer_load_dwordx4 v16, s[32:35], s76 offen lds
    s_add_u32 m0, s91, 45056
    s_nop 0
    buffer_load_dwordx4 v17, s[32:35], s76 offen lds
    s_add_u32 m0, s92, 45056
    s_nop 0
    buffer_load_dwordx4 v18, s[32:35], s76 offen lds
    s_add_u32 m0, s93, 45056
    s_nop 0
    buffer_load_dwordx4 v19, s[40:43], s77 offen lds
    s_add_u32 m0, s94, 45056
    s_nop 0
    buffer_load_dwordx4 v20, s[40:43], s77 offen lds
    s_add_u32 m0, s95, 45056
    s_nop 0
    buffer_load_dwordx4 v21, s[36:39], s78 offen lds
    s_add_u32 m0, s96, 45056
    s_nop 0
    buffer_load_dwordx4 v22, s[36:39], s78 offen lds
    s_waitcnt vmcnt(11)
    s_barrier
    s_cmp_lg_u32 s68, 0
    s_cbranch_scc1 Ll0_15
    buffer_load_dword v44, v32, s[44:47], 0 offen sc1
Ll0_15:
    s_add_u32 s74, s74, 1
    s_cmp_eq_u32 s74, 10
    s_cselect_b32 s74, 0, s74
    s_lshl_b32 s75, s74, 7
    s_mul_i32 s76, s74, 245760
    s_mul_i32 s78, s74, 196608
    s_cmp_lg_u32 s63, 0
    s_cselect_b32 s77, s78, s76
    s_add_u32 m0, s86, 90112
    s_nop 0
    buffer_load_dwordx4 v12, s[28:31], s75 offen lds
    s_add_u32 m0, s87, 90112
    s_nop 0
    buffer_load_dwordx4 v13, s[28:31], s75 offen lds
    s_add_u32 m0, s88, 90112
    s_nop 0
    buffer_load_dwordx4 v14, s[28:31], s75 offen lds
    s_add_u32 m0, s89, 90112
    s_nop 0
    buffer_load_dwordx4 v15, s[28:31], s75 offen lds
    s_add_u32 m0, s90, 90112
    s_nop 0
    buffer_load_dwordx4 v16, s[32:35], s76 offen lds
    s_add_u32 m0, s91, 90112
    s_nop 0
    buffer_load_dwordx4 v17, s[32:35], s76 offen lds
    s_add_u32 m0, s92, 90112
    s_nop 0
    buffer_load_dwordx4 v18, s[32:35], s76 offen lds
    s_add_u32 m0, s93, 90112
    s_nop 0
    buffer_load_dwordx4 v19, s[40:43], s77 offen lds
    s_add_u32 m0, s94, 90112
    s_nop 0
    buffer_load_dwordx4 v20, s[40:43], s77 offen lds
    s_add_u32 m0, s95, 90112
    s_nop 0
    buffer_load_dwordx4 v21, s[36:39], s78 offen lds
    s_add_u32 m0, s96, 90112
    s_nop 0
    buffer_load_dwordx4 v22, s[36:39], s78 offen lds
    s_waitcnt vmcnt(11)
    s_cmp_lg_u32 s68, 0
    s_cbranch_scc1 Ll0_16
    s_mov_b32 s80, 0
Lpoll_17:
    v_cmp_ne_u32 vcc, s79, v44
    s_nop 1
    s_and_b32 s70, vcc_lo, 0xfffff
    s_cbranch_scc0 Lpolld_18
    s_add_u32 s80, s80, 1
    s_cmp_gt_u32 s80, 0x40000
    s_cbranch_scc1 Lpolld_18
    buffer_load_dword v44, v32, s[44:47], 0 offen sc1
    s_waitcnt vmcnt(0)
    s_branch Lpoll_17
Lpolld_18:
Ll0_16:
    s_barrier
    s_cmp_lt_u32 s68, 2
    s_cselect_b32 s70, s61, s27
    s_mov_b32 s71, 294912
    s_cselect_b32 s71, 131072, s71
    s_mul_i32 s70, s70, 10240
    s_add_u32 s70, s70, s71
    s_and_b32 s71, s68, 1
    s_mul_i32 s71, s71, 5120
    s_add_u32 s70, s70, s71
    s_mul_i32 s72, s68, 5120
    s_add_u32 m0, s72, 135168
    s_nop 0
    buffer_load_dwordx4 v39, s[44:47], s70 offen offset:0 sc1 lds
    buffer_load_dwordx4 v39, s[44:47], s70 offen offset:1024 sc1 lds
    buffer_load_dwordx4 v39, s[44:47], s70 offen offset:2048 sc1 lds
    buffer_load_dwordx4 v39, s[44:47], s70 offen offset:3072 sc1 lds
    s_add_u32 m0, s72, 139264
    s_add_u32 s70, s70, 4096
    buffer_load_dwordx4 v39, s[44:47], s70 offen sc1 lds
    s_add_u32 s74, s74, 1
    s_cmp_eq_u32 s74, 10
    s_cselect_b32 s74, 0, s74
    s_lshl_b32 s75, s74, 7
    s_mul_i32 s76, s74, 245760
    s_mul_i32 s78, s74, 196608
    s_cmp_lg_u32 s63, 0
    s_cselect_b32 s77, s78, s76
    s_add_u32 m0, s86, 0
    s_nop 0
    buffer_load_dwordx4 v12, s[28:31], s75 offen lds
    s_add_u32 m0, s87, 0
    s_nop 0
    buffer_load_dwordx4 v13, s[28:31], s75 offen lds
    s_add_u32 m0, s88, 0
    s_nop 0
    buffer_load_dwordx4 v14, s[28:31], s75 offen lds
    s_add_u32 m0, s89, 0
    s_nop 0
    buffer_load_dwordx4 v15, s[28:31], s75 offen lds
    s_add_u32 m0, s90, 0
    s_nop 0
    buffer_load_dwordx4 v16, s[32:35], s76 offen lds
    s_add_u32 m0, s91, 0
    s_nop 0
    buffer_load_dwordx4 v17, s[32:35], s76 offen lds
    s_add_u32 m0, s92, 0
    s_nop 0
    buffer_load_dwordx4 v18, s[32:35], s76 offen lds
    s_add_u32 m0, s93, 0
    s_nop 0
    buffer_load_dwordx4 v19, s[40:43], s77 offen lds
    s_add_u32 m0, s94, 0
    s_nop 0
    buffer_load_dwordx4 v20, s[40:43], s77 offen lds
    s_add_u32 m0, s95, 0
    s_nop 0
    buffer_load_dwordx4 v21, s[36:39], s78 offen lds
    s_add_u32 m0, s96, 0
    s_nop 0
    buffer_load_dwordx4 v22, s[36:39], s78 offen lds
    s_waitcnt vmcnt(11)
    s_barrier
    s_cmp_lg_u32 s68, 0
    s_cbranch_scc1 Ll0_19
    buffer_load_dwordx2 v[64:65], v29, s[44:47], 0 offen sc1
Ll0_19:
    s_lshr_b32 s70, s68, 1
    s_mul_i32 s70, s70, 10240
    s_and_b32 s71, s68, 1
    s_lshl_b32 s71, s71, 9
    s_add_u32 s70, s70, s71
    s_add_u32 s70, s70, 135168
    v_lshl_add_u32 v6, v1, 3, s70
    ds_read_b64 v[44:45], v6 offset:0
    ds_read_b64 v[46:47], v6 offset:1024
    ds_read_b64 v[48:49], v6 offset:2048
    ds_read_b64 v[50:51], v6 offset:3072
    ds_read_b64 v[52:53], v6 offset:4096
    ds_read_b64 v[54:55], v6 offset:5120
    ds_read_b64 v[56:57], v6 offset:6144
    ds_read_b64 v[58:59], v6 offset:7168
    ds_read_b64 v[60:61], v6 offset:8192
    ds_read_b64 v[62:63], v6 offset:9216
    s_waitcnt lgkmcnt(0)
    v_add_f32 v44, v44, v46
    v_add_f32 v45, v45, v47
    v_add_f32 v44, v44, v48
    v_add_f32 v45, v45, v49
    v_add_f32 v44, v44, v50
    v_add_f32 v45, v45, v51
    v_add_f32 v44, v44, v52
    v_add_f32 v45, v45, v53
    v_add_f32 v44, v44, v54
    v_add_f32 v45, v45, v55
    v_add_f32 v44, v44, v56
    v_add_f32 v45, v45, v57
    v_add_f32 v44, v44, v58
    v_add_f32 v45, v45, v59
    v_add_f32 v44, v44, v60
    v_add_f32 v45, v45, v61
    v_add_f32 v44, v44, v62
    v_add_f32 v45, v45, v63
    s_and_b32 s71, s68, 1
    s_lshl_b32 s71, s71, 6
    v_add_u32 v53, s71, v1
    v_lshlrev_b32 v54, 3, v53
    v_add_u32 v54, 88064, v54
    v_lshlrev_b32 v53, 2, v53
    v_add_u32 v53, 86016, v53
    v_mul_f32 v46, 0x3acccccd, v44
    v_mul_f32 v47, v46, v46
    v_mov_b32 v48, 0x3acccccd
    v_fma_f32 v55, v45, v48, -v47
    v_max_f32 v55, 0, v55
    v_add_f32 v47, 0x3727c5ac, v55
    v_rsq_f32 v48, v47
    s_nop 0
    v_mul_f32 v49, v48, v48
    v_fmaak_f32 v49, v49, v55, 0x3727c5ac
    v_rsq_f32 v49, v49
    s_nop 0
    v_mul_f32 v50, v48, v49
    v_mul_f32_e64 v51, -v46, v48
    v_mul_f32_e64 v52, -v46, v50
    s_cmp_ge_u32 s68, 2
    s_cbranch_scc1 Lstc_20
    ds_write_b32 v53, v48
    ds_write_b32 v53, v51 offset:512
    ds_write_b32 v53, v50 offset:1024
    ds_write_b32 v53, v52 offset:1536
    s_branch Lstd_21
Lstc_20:
    ds_write_b64 v54, v[44:45]
Lstd_21:
    s_cmp_lg_u32 s68, 0
    s_cbranch_scc1 Ll0_22
    v_mov_b32 v6, 89088
    ds_write2_b32 v6, v41, v42 offset1:1
    ds_write_b32 v6, v42 offset:8
Ll0_22:
    s_mov_b32 s56, s18
    s_and_b32 s57, s19, 0xffff
    s_mov_b32 s58, 0x500
    s_mov_b32 s59, 0x20000
    s_cmp_lg_u32 s68, 3
    s_cbranch_scc1 Ll0_23
    s_mul_i32 s71, s65, 160
    v_lshlrev_b32 v6, 2, v1
    s_mov_b32 m0, 89344
    s_nop 0
    buffer_load_dword v6, s[56:59], s71 offen lds
Ll0_23:
    s_mul_i32 s70, s65, 348160
    s_and_b32 s71, s68, 1
    s_mul_i32 s71, s71, 5120
    s_add_u32 s70, s70, s71
    s_add_u32 s70, s70, 2097152
    v_add_u32 v23, s70, v39
    s_mul_i32 s86, s68, 5120
    s_lshr_b32 s71, s68, 1
    s_mul_i32 s77, s71, 122880
    s_mul_i32 s78, s71, 51200
    s_add_u32 s78, s78, 245760
    s_lshr_b32 s71, s67, 3
    s_mul_i32 s74, s71, 0
    s_and_b32 s71, s67, 7
    s_mul_i32 s71, s71, 1
    s_add_u32 s74, s74, s71
    s_waitcnt vmcnt(0)
    s_cmp_lg_u32 s68, 0
    s_cbranch_scc1 Ll0_24
    s_mov_b32 s80, 0
Lpoll_25:
    v_cmp_ne_u32 vcc, s79, v64
    v_cmp_ne_u32 s[84:85], s79, v65
    s_nop 1
    s_or_b64 vcc, vcc, s[84:85]
    s_and_b32 s70, vcc_hi, 0x3
    s_or_b32 s70, s70, vcc_lo
    s_cbranch_scc0 Lpolld_26
    s_add_u32 s80, s80, 1
    s_cmp_gt_u32 s80, 0x40000
    s_cbranch_scc1 Lpolld_26
    buffer_load_dwordx2 v[64:65], v29, s[44:47], 0 offen sc1
    s_waitcnt vmcnt(0)
    s_branch Lpoll_25
Lpolld_26:
Ll0_24:
    s_waitcnt lgkmcnt(0)
    s_barrier
    s_add_u32 s75, s74, 0
    s_and_b32 s75, s75, 3
    s_mul_i32 s75, s75, 3
    s_add_u32 s75, s75, 1
    s_mul_i32 s75, s75, 10240
    s_add_u32 s75, s75, s77
    s_add_u32 m0, s86, 45056
    s_nop 0
    buffer_load_dwordx4 v23, s[44:47], s75 offen offset:0 sc1 lds
    buffer_load_dwordx4 v23, s[44:47], s75 offen offset:1024 sc1 lds
    buffer_load_dwordx4 v23, s[44:47], s75 offen offset:2048 sc1 lds
    buffer_load_dwordx4 v23, s[44:47], s75 offen offset:3072 sc1 lds
    s_add_u32 m0, s86, 49152
    s_add_u32 s75, s75, 4096
    buffer_load_dwordx4 v23, s[44:47], s75 offen sc1 lds
    s_add_u32 s75, s74, 1
    s_and_b32 s75, s75, 3
    s_mul_i32 s75, s75, 3
    s_add_u32 s75, s75, 1
    s_mul_i32 s75, s75, 10240
    s_add_u32 s75, s75, s77
    s_add_u32 m0, s86, 65536
    s_nop 0
    buffer_load_dwordx4 v23, s[44:47], s75 offen offset:0 sc1 lds
    buffer_load_dwordx4 v23, s[44:47], s75 offen offset:1024 sc1 lds
    buffer_load_dwordx4 v23, s[44:47], s75 offen offset:2048 sc1 lds
    buffer_load_dwordx4 v23, s[44:47], s75 offen offset:3072 sc1 lds
    s_add_u32 m0, s86, 69632
    s_add_u32 s75, s75, 4096
    buffer_load_dwordx4 v23, s[44:47], s75 offen sc1 lds
    s_waitcnt lgkmcnt(0)
    s_barrier
    s_setprio 0
    s_lshr_b32 s70, s68, 1
    s_mul_i32 s70, s70, 86016
    s_lshl_b32 s71, s68, 11
    s_add_u32 s70, s70, s71
    s_add_u32 s70, s70, 40960
    v_add_u32 v6, s70, v39
    v_mov_b32 v44, 0
    v_mov_b32 v45, 0
    v_mov_b32 v46, 0
    v_mov_b32 v47, 0
    ds_write_b128 v6, v[44:47]
    ds_write_b128 v6, v[44:47] offset:1024
    s_add_u32 s75, s74, 2
    s_and_b32 s75, s75, 3
    s_mul_i32 s75, s75, 3
    s_add_u32 s75, s75, 1
    s_mul_i32 s75, s75, 10240
    s_add_u32 s75, s75, s77
    s_add_u32 m0, s86, 90112
    s_nop 0
    buffer_load_dwordx4 v23, s[44:47], s75 offen offset:0 sc1 lds
    buffer_load_dwordx4 v23, s[44:47], s75 offen offset:1024 sc1 lds
    buffer_load_dwordx4 v23, s[44:47], s75 offen offset:2048 sc1 lds
    buffer_load_dwordx4 v23, s[44:47], s75 offen offset:3072 sc1 lds
    s_add_u32 m0, s86, 94208
    s_add_u32 s75, s75, 4096
    buffer_load_dwordx4 v23, s[44:47], s75 offen sc1 lds
    s_add_u32 s75, s74, 3
    s_and_b32 s75, s75, 3
    s_mul_i32 s75, s75, 3
    s_add_u32 s75, s75, 1
    s_mul_i32 s75, s75, 10240
    s_add_u32 s75, s75, s77
    s_add_u32 m0, s86, 110592
    s_nop 0
    buffer_load_dwordx4 v23, s[44:47], s75 offen offset:0 sc1 lds
    buffer_load_dwordx4 v23, s[44:47], s75 offen offset:1024 sc1 lds
    buffer_load_dwordx4 v23, s[44:47], s75 offen offset:2048 sc1 lds
    buffer_load_dwordx4 v23, s[44:47], s75 offen offset:3072 sc1 lds
    s_add_u32 m0, s86, 114688
    s_add_u32 s75, s75, 4096
    buffer_load_dwordx4 v23, s[44:47], s75 offen sc1 lds
    s_add_u32 s75, s74, 4
    s_and_b32 s75, s75, 3
    s_mul_i32 s75, s75, 3
    s_add_u32 s75, s75, 2
    s_mul_i32 s75, s75, 10240
    s_add_u32 s75, s75, s77
    s_add_u32 m0, s86, 0
    s_nop 0
    buffer_load_dwordx4 v23, s[44:47], s75 offen offset:0 sc1 lds
    buffer_load_dwordx4 v23, s[44:47], s75 offen offset:1024 sc1 lds
    buffer_load_dwordx4 v23, s[44:47], s75 offen offset:2048 sc1 lds
    buffer_load_dwordx4 v23, s[44:47], s75 offen offset:3072 sc1 lds
    s_add_u32 m0, s86, 4096
    s_add_u32 s75, s75, 4096
    buffer_load_dwordx4 v23, s[44:47], s75 offen sc1 lds
    s_add_u32 s75, s74, 5
    s_and_b32 s75, s75, 3
    s_mul_i32 s75, s75, 3
    s_add_u32 s75, s75, 2
    s_mul_i32 s75, s75, 10240
    s_add_u32 s75, s75, s77
    s_add_u32 m0, s86, 20480
    s_nop 0
    buffer_load_dwordx4 v23, s[44:47], s75 offen offset:0 sc1 lds
    buffer_load_dwordx4 v23, s[44:47], s75 offen offset:1024 sc1 lds
    buffer_load_dwordx4 v23, s[44:47], s75 offen offset:2048 sc1 lds
    buffer_load_dwordx4 v23, s[44:47], s75 offen offset:3072 sc1 lds
    s_add_u32 m0, s86, 24576
    s_add_u32 s75, s75, 4096
    buffer_load_dwordx4 v23, s[44:47], s75 offen sc1 lds
    v_mov_b32 v6, 89088
    ds_read_b32 v41, v6
    s_cmp_lg_u32 s63, 0
    s_cbranch_scc1 Lld_eq
    s_barrier
Lld_eq:
    s_waitcnt lgkmcnt(0)
    s_cmp_lg_u32 s68, 0
    s_cbranch_scc1 Ll0_27
    s_setprio 3
    s_cmp_eq_u32 s63, 0
    s_cbranch_scc1 Lfk_28
    v_mov_b32 v6, 89092
    s_mov_b32 s80, 0
Lc8r_30:
    ds_read_b32 v7, v6
    s_waitcnt lgkmcnt(0)
    v_readfirstlane_b32 s70, v7
    s_nop 1
    s_cmp_ge_u32 s70, 4
    s_cbranch_scc1 Lc8g_31
    s_sleep 1
    s_add_u32 s80, s80, 1
    s_cmp_lt_u32 s80, 0x400000
    s_cbranch_scc1 Lc8r_30
Lc8g_31:
    buffer_store_dword v41, v24, s[44:47], 0 offen sc1
    s_waitcnt vmcnt(0)
    buffer_load_dword v44, v30, s[44:47], 0 offen sc1
    v_mov_b32 v6, 89096
    s_mov_b32 s80, 0
Lc8r_32:
    ds_read_b32 v7, v6
    s_waitcnt lgkmcnt(0)
    v_readfirstlane_b32 s70, v7
    s_nop 1
    s_cmp_ge_u32 s70, 4
    s_cbranch_scc1 Lc8g_33
    s_sleep 1
    s_add_u32 s80, s80, 1
    s_cmp_lt_u32 s80, 0x400000
    s_cbranch_scc1 Lc8r_32
Lc8g_33:
    buffer_store_dword v41, v24, s[44:47], 0 offen offset:1024 sc1
    s_branch Lfj_29
Lfk_28:
    v_mov_b32 v6, 89096
    s_mov_b32 s80, 0
Lc8r_34:
    ds_read_b32 v7, v6
    s_waitcnt lgkmcnt(0)
    v_readfirstlane_b32 s70, v7
    s_nop 1
    s_cmp_ge_u32 s70, 4
    s_cbranch_scc1 Lc8g_35
    s_sleep 1
    s_add_u32 s80, s80, 1
    s_cmp_lt_u32 s80, 0x400000
    s_cbranch_scc1 Lc8r_34
Lc8g_35:
    buffer_load_dword v44, v30, s[44:47], 0 offen sc1
Lfj_29:
    s_waitcnt vmcnt(0)
    s_mov_b32 s80, 0
Lpoll_36:
    v_cmp_ne_u32 vcc, s79, v44
    s_nop 1
    s_and_b32 s70, vcc_lo, 0xff
    s_cbranch_scc0 Lpolld_37
    s_add_u32 s80, s80, 1
    s_cmp_gt_u32 s80, 0x40000
    s_cbranch_scc1 Lpolld_37
    buffer_load_dword v44, v30, s[44:47], 0 offen sc1
    s_waitcnt vmcnt(0)
    s_branch Lpoll_36
Lpolld_37:
    s_setprio 0
Ll0_27:
    s_cmp_lg_u32 s68, 2
    s_cbranch_scc1 Ll1s_38
    s_cmp_lg_u32 s63, 0
    s_cbranch_scc1 Ll1s_38
    s_cmp_ge_u32 s61, 14
    s_cbranch_scc1 Ll1s_38
    s_mul_i32 s71, s62, 6784
    s_lshl_b32 s72, s71, 4
    s_add_u32 s71, s71, 1572864
    s_add_u32 s72, s72, 524288
    v_lshrrev_b32 v89, 8, v41
    v_lshrrev_b32 v90, 16, v41
    v_lshrrev_b32 v91, 24, v41
    v_mov_b32 v88, v41
    v_mov_b32 v92, 0xffffff00
    v_mov_b32 v6, 89096
    s_mov_b32 s80, 0
Lc8r_41:
    ds_read_b32 v7, v6
    s_waitcnt lgkmcnt(0)
    v_readfirstlane_b32 s70, v7
    s_nop 1
    s_cmp_ge_u32 s70, 4
    s_cbranch_scc1 Lc8g_42
    s_sleep 1
    s_add_u32 s80, s80, 1
    s_cmp_lt_u32 s80, 0x400000
    s_cbranch_scc1 Lc8r_41
Lc8g_42:
    s_mov_b32 s80, 0
Ll1r_39:
    s_add_u32 s73, s72, 0
    buffer_load_dwordx4 v[48:51], v3, s[44:47], s73 offen sc1
    s_add_u32 s73, s72, 6784
    buffer_load_dwordx4 v[52:55], v3, s[44:47], s73 offen sc1
    s_add_u32 s73, s72, 13568
    buffer_load_dwordx4 v[56:59], v3, s[44:47], s73 offen sc1
    s_add_u32 s73, s72, 20352
    buffer_load_dwordx4 v[60:63], v3, s[44:47], s73 offen sc1
    s_add_u32 s73, s72, 27136
    buffer_load_dwordx4 v[64:67], v3, s[44:47], s73 offen sc1
    s_add_u32 s73, s72, 33920
    buffer_load_dwordx4 v[68:71], v3, s[44:47], s73 offen sc1
    s_add_u32 s73, s72, 40704
    buffer_load_dwordx4 v[72:75], v3, s[44:47], s73 offen sc1
    s_add_u32 s73, s72, 47488
    buffer_load_dwordx4 v[76:79], v3, s[44:47], s73 offen sc1
    s_cmp_lg_u32 s80, 0
    s_cbranch_scc1 Ll1b_43
    s_waitcnt vmcnt(8)
    s_barrier
Ll1b_43:
    s_waitcnt vmcnt(7)
    v_xor_b32 v84, v48, v88
    v_xor_b32 v85, v49, v89
    v_xor_b32 v86, v50, v90
    v_xor_b32 v87, v51, v91
    v_and_b32 v48, v92, v48
    v_and_b32 v49, v92, v49
    v_and_b32 v50, v92, v50
    v_and_b32 v51, v92, v51
    s_waitcnt vmcnt(6)
    v_bitop3_b32 v84, v84, v52, v88 bitop3:0xf6
    v_bitop3_b32 v85, v85, v53, v89 bitop3:0xf6
    v_bitop3_b32 v86, v86, v54, v90 bitop3:0xf6
    v_bitop3_b32 v87, v87, v55, v91 bitop3:0xf6
    v_and_b32 v52, v92, v52
    v_and_b32 v53, v92, v53
    v_and_b32 v54, v92, v54
    v_and_b32 v55, v92, v55
    v_add_f32 v48, v48, v52
    v_add_f32 v49, v49, v53
    v_add_f32 v50, v50, v54
    v_add_f32 v51, v51, v55
    s_waitcnt vmcnt(5)
    v_bitop3_b32 v84, v84, v56, v88 bitop3:0xf6
    v_bitop3_b32 v85, v85, v57, v89 bitop3:0xf6
    v_bitop3_b32 v86, v86, v58, v90 bitop3:0xf6
    v_bitop3_b32 v87, v87, v59, v91 bitop3:0xf6
    v_and_b32 v56, v92, v56
    v_and_b32 v57, v92, v57
    v_and_b32 v58, v92, v58
    v_and_b32 v59, v92, v59
    v_add_f32 v48, v48, v56
    v_add_f32 v49, v49, v57
    v_add_f32 v50, v50, v58
    v_add_f32 v51, v51, v59
    s_waitcnt vmcnt(4)
    v_bitop3_b32 v84, v84, v60, v88 bitop3:0xf6
    v_bitop3_b32 v85, v85, v61, v89 bitop3:0xf6
    v_bitop3_b32 v86, v86, v62, v90 bitop3:0xf6
    v_bitop3_b32 v87, v87, v63, v91 bitop3:0xf6
    v_and_b32 v60, v92, v60
    v_and_b32 v61, v92, v61
    v_and_b32 v62, v92, v62
    v_and_b32 v63, v92, v63
    v_add_f32 v48, v48, v60
    v_add_f32 v49, v49, v61
    v_add_f32 v50, v50, v62
    v_add_f32 v51, v51, v63
    s_waitcnt vmcnt(3)
    v_bitop3_b32 v84, v84, v64, v88 bitop3:0xf6
    v_bitop3_b32 v85, v85, v65, v89 bitop3:0xf6
    v_bitop3_b32 v86, v86, v66, v90 bitop3:0xf6
    v_bitop3_b32 v87, v87, v67, v91 bitop3:0xf6
    v_and_b32 v64, v92, v64
    v_and_b32 v65, v92, v65
    v_and_b32 v66, v92, v66
    v_and_b32 v67, v92, v67
    v_add_f32 v48, v48, v64
    v_add_f32 v49, v49, v65
    v_add_f32 v50, v50, v66
    v_add_f32 v51, v51, v67
    s_waitcnt vmcnt(2)
    v_bitop3_b32 v84, v84, v68, v88 bitop3:0xf6
    v_bitop3_b32 v85, v85, v69, v89 bitop3:0xf6
    v_bitop3_b32 v86, v86, v70, v90 bitop3:0xf6
    v_bitop3_b32 v87, v87, v71, v91 bitop3:0xf6
    v_and_b32 v68, v92, v68
    v_and_b32 v69, v92, v69
    v_and_b32 v70, v92, v70
    v_and_b32 v71, v92, v71
    v_add_f32 v48, v48, v68
    v_add_f32 v49, v49, v69
    v_add_f32 v50, v50, v70
    v_add_f32 v51, v51, v71
    s_waitcnt vmcnt(1)
    v_bitop3_b32 v84, v84, v72, v88 bitop3:0xf6
    v_bitop3_b32 v85, v85, v73, v89 bitop3:0xf6
    v_bitop3_b32 v86, v86, v74, v90 bitop3:0xf6
    v_bitop3_b32 v87, v87, v75, v91 bitop3:0xf6
    v_and_b32 v72, v92, v72
    v_and_b32 v73, v92, v73
    v_and_b32 v74, v92, v74
    v_and_b32 v75, v92, v75
    v_add_f32 v48, v48, v72
    v_add_f32 v49, v49, v73
    v_add_f32 v50, v50, v74
    v_add_f32 v51, v51, v75
    s_waitcnt vmcnt(0)
    v_bitop3_b32 v84, v84, v76, v88 bitop3:0xf6
    v_bitop3_b32 v85, v85, v77, v89 bitop3:0xf6
    v_bitop3_b32 v86, v86, v78, v90 bitop3:0xf6
    v_bitop3_b32 v87, v87, v79, v91 bitop3:0xf6
    v_and_b32 v76, v92, v76
    v_and_b32 v77, v92, v77
    v_and_b32 v78, v92, v78
    v_and_b32 v79, v92, v79
    v_add_f32 v48, v48, v76
    v_add_f32 v49, v49, v77
    v_add_f32 v50, v50, v78
    v_add_f32 v51, v51, v79
    v_or3_b32 v84, v84, v85, v86
    v_or_b32 v84, v84, v87
    v_and_b32 v84, 0xff, v84
    v_cmp_ne_u32 vcc, 0, v84
    s_nop 1
    s_and_b64 vcc, vcc, s[8:9]
    s_cbranch_scc0 Ll1g_40
    s_add_u32 s80, s80, 1
    s_cmp_lt_u32 s80, 0x40000
    s_cbranch_scc1 Ll1r_39
Ll1g_40:
    v_mov_b32 v52, v48
    v_mov_b32 v53, v49
    v_mov_b32 v54, v50
    v_mov_b32 v55, v51
    v_permlane32_swap_b32 v52, v48
    v_permlane32_swap_b32 v53, v49
    v_permlane32_swap_b32 v54, v50
    v_permlane32_swap_b32 v55, v51
    v_add_f32 v48, v48, v52
    v_add_f32 v49, v49, v53
    v_add_f32 v50, v50, v54
    v_add_f32 v51, v51, v55
    v_cvt_pk_bf16_f32 v48, v48, v49
    v_cvt_pk_bf16_f32 v49, v50, v51
    v_mov_b32 v50, v41
    v_mov_b32 v51, v41
    buffer_store_dwordx4 v[48:51], v4, s[44:47], s71 offen sc1
    s_branch Ll1s_38x
Ll1s_38:
    s_waitcnt vmcnt(0)
    s_barrier
Ll1s_38x:
    s_setprio 0
    s_bitcmp1_b32 s68, 0
    s_cbranch_scc1 Lring
    s_barrier
    s_cmp_lg_u32 s68, 0
    s_cbranch_scc1 Ll0_44
    s_cmp_lg_u32 s63, 0
    s_cbranch_scc1 Ll0_44
    buffer_store_dword v41, v24, s[44:47], 0 offen sc1
Ll0_44:
    s_cmp_lg_u32 s68, 0
    s_cbranch_scc1 Ll0_45
    buffer_load_dword v46, v33, s[44:47], 0 offen sc1
Ll0_45:
    s_cmp_lg_u32 s68, 0
    s_cbranch_scc1 Ll0_46
    s_waitcnt vmcnt(0)
    s_mov_b32 s80, 0
Lpoll_47:
    v_cmp_ne_u32 vcc, s79, v46
    s_nop 1
    s_and_b32 s70, vcc_lo, 0xff
    s_cbranch_scc0 Lpolld_48
    s_add_u32 s80, s80, 1
    s_cmp_gt_u32 s80, 0x40000
    s_cbranch_scc1 Lpolld_48
    buffer_load_dword v46, v33, s[44:47], 0 offen sc1
    s_waitcnt vmcnt(0)
    s_branch Lpoll_47
Lpolld_48:
Ll0_46:
    s_barrier
    s_cmp_eq_u32 s63, 0
    s_cbranch_scc1 Liq_49
    buffer_load_dwordx4 v[48:51], v8, s[44:47], s100 offen sc1
    buffer_load_dwordx4 v[52:55], v9, s[44:47], s100 offen sc1
Liq_49:
    s_cmp_eq_u32 s63, 0
    s_cbranch_scc1 Liq_50
    s_waitcnt vmcnt(0)
    s_mov_b32 s80, 0
Lkr_51:
    v_cmp_ne_u32 vcc, v50, v41
    v_cmp_ne_u32 s[84:85], v54, v41
    s_nop 1
    s_and_b64 s[84:85], s[84:85], s[8:9]
    s_or_b64 vcc, vcc, s[84:85]
    s_cbranch_scc0 Lkg_52
    s_add_u32 s80, s80, 1
    s_cmp_gt_u32 s80, 0x40000
    s_cbranch_scc1 Lkg_52
    buffer_load_dwordx4 v[48:51], v8, s[44:47], s100 offen sc1
    buffer_load_dwordx4 v[52:55], v9, s[44:47], s100 offen sc1
    s_waitcnt vmcnt(0)
    s_branch Lkr_51
Lkg_52:
    ds_write_b64 v34, v[48:49]
    s_mov_b64 exec, s[10:11]
    s_cbranch_execz Lkz_53
    v_add_u32 v34, v34, v36
    ds_write_b64 v34, v[48:49]
    v_add_u32 v34, v34, v36
    ds_write_b64 v34, v[48:49]
    v_add_u32 v34, v34, v36
    ds_write_b64 v34, v[48:49]
Lkz_53:
    s_mov_b64 exec, -1
    s_mov_b64 exec, s[8:9]
    s_cbranch_execz Lkz_54
    ds_write_b64 v35, v[52:53]
    s_mov_b64 exec, s[16:17]
    s_cbranch_execz Lkz_54
    v_add_u32 v35, v35, v37
    ds_write_b64 v35, v[52:53]
    v_add_u32 v35, v35, v37
    ds_write_b64 v35, v[52:53]
    v_add_u32 v35, v35, v37
    ds_write_b64 v35, v[52:53]
Lkz_54:
    s_mov_b64 exec, -1
    s_waitcnt lgkmcnt(0)
Liq_50:
    s_barrier
    s_cmp_lg_u32 s68, 0
    s_cbranch_scc1 Ll0_55
    buffer_load_dword v45, v28, s[44:47], 0 offen sc1
Ll0_55:
    s_cmp_lg_u32 s68, 0
    s_cbranch_scc1 Ll0_56
    s_waitcnt vmcnt(0)
    s_mov_b32 s80, 0
Lpoll_57:
    v_cmp_ne_u32 vcc, s79, v45
    s_nop 1
    s_and_b32 s70, vcc_lo, 0xff
    s_cbranch_scc0 Lpolld_58
    s_add_u32 s80, s80, 1
    s_cmp_gt_u32 s80, 0x40000
    s_cbranch_scc1 Lpolld_58
    buffer_load_dword v45, v28, s[44:47], 0 offen sc1
    s_waitcnt vmcnt(0)
    s_branch Lpoll_57
Lpolld_58:
Ll0_56:
    s_barrier
    s_cmp_eq_u32 s63, 0
    s_cbranch_scc1 Liq_59
    ds_read_b64 v[104:105], v38 offset:0
    ds_read_b64 v[106:107], v38 offset:32
    ds_read_b64 v[108:109], v38 offset:64
    ds_read_b64 v[110:111], v38 offset:96
    ds_read_b64 v[112:113], v38 offset:128
    ds_read_b64 v[116:117], v38 offset:2688
    ds_read_b64 v[118:119], v38 offset:2720
    ds_read_b64 v[120:121], v38 offset:2752
    ds_read_b64 v[122:123], v38 offset:2784
    ds_read_b64 v[124:125], v38 offset:2816
    ds_read_b64 v[128:129], v38 offset:5376
    ds_read_b64 v[130:131], v38 offset:5408
    ds_read_b64 v[132:133], v38 offset:5440
    ds_read_b64 v[134:135], v38 offset:5472
    ds_read_b64 v[136:137], v38 offset:5504
    ds_read_b64 v[140:141], v38 offset:8064
    ds_read_b64 v[142:143], v38 offset:8096
    ds_read_b64 v[144:145], v38 offset:8128
    ds_read_b64 v[146:147], v38 offset:8160
    ds_read_b64 v[148:149], v38 offset:8192
    v_lshlrev_b32 v6, 3, v1
    s_waitcnt lgkmcnt(15)
    buffer_store_dwordx4 v[104:107], v39, s[44:47], s101 offen sc1
    buffer_store_dwordx4 v[108:111], v39, s[44:47], s101 offen offset:1024 sc1
    buffer_store_dwordx2 v[112:113], v6, s[44:47], s101 offen offset:2048 sc1
    s_add_u32 s101, s101, 20480
    s_waitcnt lgkmcnt(10)
    buffer_store_dwordx4 v[116:119], v39, s[44:47], s101 offen sc1
    buffer_store_dwordx4 v[120:123], v39, s[44:47], s101 offen offset:1024 sc1
    buffer_store_dwordx2 v[124:125], v6, s[44:47], s101 offen offset:2048 sc1
    s_add_u32 s101, s101, 20480
    s_waitcnt lgkmcnt(5)
    buffer_store_dwordx4 v[128:131], v39, s[44:47], s101 offen sc1
    buffer_store_dwordx4 v[132:135], v39, s[44:47], s101 offen offset:1024 sc1
    buffer_store_dwordx2 v[136:137], v6, s[44:47], s101 offen offset:2048 sc1
    s_add_u32 s101, s101, 20480
    s_waitcnt lgkmcnt(0)
    buffer_store_dwordx4 v[140:143], v39, s[44:47], s101 offen sc1
    buffer_store_dwordx4 v[144:147], v39, s[44:47], s101 offen offset:1024 sc1
    buffer_store_dwordx2 v[148:149], v6, s[44:47], s101 offen offset:2048 sc1
Liq_59:
    s_barrier
    s_waitcnt vmcnt(0)
    s_barrier
    s_cmp_lg_u32 s68, 0
    s_cbranch_scc1 Ll0_60
    buffer_store_dword v41, v25, s[44:47], 0 offen sc1
Ll0_60:
    s_barrier
    s_barrier
    s_barrier
    s_mul_i32 s70, s64, 81920
    s_mul_i32 s71, s65, 160
    s_add_u32 s71, s70, s71
    s_mul_i32 s72, s68, 160
    s_mul_i32 s73, s68, 2560
    v_add_u32 v6, s72, v1
    v_mul_u32_u24 v7, 6554, v6
    v_lshrrev_b32 v7, 16, v7
    v_mul_u32_u24 v7, 1120, v7
    v_lshl_add_u32 v7, v6, 4, v7
    s_add_u32 m0, s73, 135168
    s_nop 0
    buffer_load_dwordx4 v7, s[28:31], s71 offen lds
    v_add_u32 v6, s72, v1
    v_add_u32 v6, 64, v6
    v_mul_u32_u24 v7, 6554, v6
    v_lshrrev_b32 v7, 16, v7
    v_mul_u32_u24 v7, 1120, v7
    v_lshl_add_u32 v7, v6, 4, v7
    s_add_u32 m0, s73, 136192
    s_nop 0
    buffer_load_dwordx4 v7, s[28:31], s71 offen lds
    v_add_u32 v6, s72, v1
    v_add_u32 v6, 128, v6
    v_mul_u32_u24 v7, 6554, v6
    v_lshrrev_b32 v7, 16, v7
    v_mul_u32_u24 v7, 1120, v7
    v_lshl_add_u32 v7, v6, 4, v7
    s_add_u32 m0, s73, 137216
    s_nop 0
    buffer_load_dwordx4 v7, s[28:31], s71 offen lds
    v_add_u32 v6, s72, v1
    v_add_u32 v6, 192, v6
    v_mul_u32_u24 v7, 6554, v6
    v_lshrrev_b32 v7, 16, v7
    v_mul_u32_u24 v7, 1120, v7
    v_lshl_add_u32 v7, v6, 4, v7
    s_add_u32 m0, s73, 138240
    s_nop 0
    buffer_load_dwordx4 v7, s[28:31], s71 offen lds
    v_add_u32 v6, s72, v1
    v_add_u32 v6, 256, v6
    v_mul_u32_u24 v7, 6554, v6
    v_lshrrev_b32 v7, 16, v7
    v_mul_u32_u24 v7, 1120, v7
    v_lshl_add_u32 v7, v6, 4, v7
    s_add_u32 m0, s73, 139264
    s_nop 0
    buffer_load_dwordx4 v7, s[28:31], s71 offen lds
    s_barrier
    s_barrier
    s_cmp_lg_u32 s68, 0
    s_cbranch_scc1 Ll0_61
    buffer_load_dword v44, v31, s[44:47], 0 offen sc1
Ll0_61:
    s_cmp_lg_u32 s68, 0
    s_cbranch_scc1 Ll0_62
    s_waitcnt vmcnt(0)
    s_mov_b32 s80, 0
Lpoll_63:
    v_cmp_ne_u32 vcc, s79, v44
    s_nop 1
    s_and_b32 s70, vcc_lo, 0xff
    s_cbranch_scc0 Lpolld_64
    s_add_u32 s80, s80, 1
    s_cmp_gt_u32 s80, 0x40000
    s_cbranch_scc1 Lpolld_64
    buffer_load_dword v44, v31, s[44:47], 0 offen sc1
    s_waitcnt vmcnt(0)
    s_branch Lpoll_63
Lpolld_64:
Ll0_62:
    s_barrier
    s_mov_b32 s52, s20
    s_and_b32 s53, s21, 0xffff
    s_mov_b32 s54, 0x280000
    s_mov_b32 s55, 0x20000
    v_add_u32 v12, 0, v0
    v_mul_u32_u24 v165, 6554, v12
    v_lshrrev_b32 v165, 16, v165
    v_lshlrev_b32 v164, 4, v12
    v_mad_u32_u24 v13, v165, 8, v164
    v_mul_u32_u24 v165, 1120, v165
    v_add_u32 v165, v165, v164
    v_add_u32 v164, 145408, v13
    v_add_u32 v12, 256, v0
    v_mul_u32_u24 v163, 6554, v12
    v_lshrrev_b32 v163, 16, v163
    v_lshlrev_b32 v162, 4, v12
    v_mad_u32_u24 v13, v163, 8, v162
    v_mul_u32_u24 v163, 1120, v163
    v_add_u32 v163, v163, v162
    v_add_u32 v162, 145408, v13
    s_mul_i32 s83, s64, 81920
    s_mul_i32 s71, s65, 160
    s_add_u32 s83, s83, s71
    s_waitcnt vmcnt(0)
    s_barrier
    s_barrier
    s_barrier
    s_cmp_ge_u32 s60, 2
    s_cbranch_scc1 Llf_65
    ds_read_b64 v[12:13], v162
    ds_read_b64 v[14:15], v162 offset:8
    s_waitcnt lgkmcnt(0)
    buffer_store_dwordx4 v[12:15], v163, s[52:55], s83 offen
Llf_65:
    ds_read_b64 v[4:5], v164
    ds_read_b64 v[6:7], v164 offset:8
    s_waitcnt lgkmcnt(0)
    buffer_store_dwordx4 v[4:7], v165, s[52:55], s83 offen
    s_endpgm
Lring:
    v_add_u32 v23, 4294962176, v23
    s_sub_u32 s86, s86, 5120
    s_add_u32 s70, s86, 0
    v_add_u32 v2, s70, v39
    s_add_u32 s70, s86, 45056
    v_add_u32 v3, s70, v39
    s_add_u32 s70, s86, 90112
    v_add_u32 v4, s70, v39
    s_barrier
    s_add_u32 s75, s74, 6
    s_and_b32 s75, s75, 3
    s_mul_i32 s75, s75, 3
    s_add_u32 s75, s75, 2
    s_mul_i32 s75, s75, 10240
    s_add_u32 s75, s75, s77
    s_add_u32 m0, s86, 45056
    s_nop 0
    buffer_load_dwordx4 v23, s[44:47], s75 offen offset:0 sc1 lds
    buffer_load_dwordx4 v23, s[44:47], s75 offen offset:1024 sc1 lds
    buffer_load_dwordx4 v23, s[44:47], s75 offen offset:2048 sc1 lds
    buffer_load_dwordx4 v23, s[44:47], s75 offen offset:3072 sc1 lds
    s_add_u32 m0, s86, 49152
    s_add_u32 s75, s75, 4096
    buffer_load_dwordx4 v23, s[44:47], s75 offen offset:0 sc1 lds
    buffer_load_dwordx4 v23, s[44:47], s75 offen offset:1024 sc1 lds
    buffer_load_dwordx4 v23, s[44:47], s75 offen offset:2048 sc1 lds
    buffer_load_dwordx4 v23, s[44:47], s75 offen offset:3072 sc1 lds
    s_add_u32 m0, s86, 53248
    s_add_u32 s75, s75, 4096
    buffer_load_dwordx4 v23, s[44:47], s75 offen offset:0 sc1 lds
    buffer_load_dwordx4 v23, s[44:47], s75 offen offset:1024 sc1 lds
    s_barrier
    s_cmp_eq_u32 s63, 0
    s_cbranch_scc1 Liq_66
    buffer_load_dwordx4 v[48:51], v8, s[44:47], s100 offen sc1
    buffer_load_dwordx4 v[52:55], v9, s[44:47], s100 offen sc1
Liq_66:
    s_add_u32 s75, s74, 7
    s_and_b32 s75, s75, 3
    s_mul_i32 s75, s75, 3
    s_add_u32 s75, s75, 2
    s_mul_i32 s75, s75, 10240
    s_add_u32 s75, s75, s77
    s_add_u32 m0, s86, 65536
    s_nop 0
    buffer_load_dwordx4 v23, s[44:47], s75 offen offset:0 sc1 lds
    buffer_load_dwordx4 v23, s[44:47], s75 offen offset:1024 sc1 lds
    buffer_load_dwordx4 v23, s[44:47], s75 offen offset:2048 sc1 lds
    buffer_load_dwordx4 v23, s[44:47], s75 offen offset:3072 sc1 lds
    s_add_u32 m0, s86, 69632
    s_add_u32 s75, s75, 4096
    buffer_load_dwordx4 v23, s[44:47], s75 offen offset:0 sc1 lds
    buffer_load_dwordx4 v23, s[44:47], s75 offen offset:1024 sc1 lds
    buffer_load_dwordx4 v23, s[44:47], s75 offen offset:2048 sc1 lds
    buffer_load_dwordx4 v23, s[44:47], s75 offen offset:3072 sc1 lds
    s_add_u32 m0, s86, 73728
    s_add_u32 s75, s75, 4096
    buffer_load_dwordx4 v23, s[44:47], s75 offen offset:0 sc1 lds
    buffer_load_dwordx4 v23, s[44:47], s75 offen offset:1024 sc1 lds
    s_cmp_eq_u32 s63, 0
    s_cbranch_scc1 Liq_67
    s_waitcnt vmcnt(10)
    s_mov_b32 s80, 0
Lkr_68:
    v_cmp_ne_u32 vcc, v50, v41
    v_cmp_ne_u32 s[84:85], v54, v41
    s_nop 1
    s_and_b64 s[84:85], s[84:85], s[8:9]
    s_or_b64 vcc, vcc, s[84:85]
    s_cbranch_scc0 Lkg_69
    s_add_u32 s80, s80, 1
    s_cmp_gt_u32 s80, 0x40000
    s_cbranch_scc1 Lkg_69
    buffer_load_dwordx4 v[48:51], v8, s[44:47], s100 offen sc1
    buffer_load_dwordx4 v[52:55], v9, s[44:47], s100 offen sc1
    s_waitcnt vmcnt(0)
    s_branch Lkr_68
Lkg_69:
    ds_write_b64 v34, v[48:49]
    s_mov_b64 exec, s[10:11]
    s_cbranch_execz Lkz_70
    v_add_u32 v34, v34, v36
    ds_write_b64 v34, v[48:49]
    v_add_u32 v34, v34, v36
    ds_write_b64 v34, v[48:49]
    v_add_u32 v34, v34, v36
    ds_write_b64 v34, v[48:49]
Lkz_70:
    s_mov_b64 exec, -1
    s_mov_b64 exec, s[8:9]
    s_cbranch_execz Lkz_71
    ds_write_b64 v35, v[52:53]
    s_mov_b64 exec, s[16:17]
    s_cbranch_execz Lkz_71
    v_add_u32 v35, v35, v37
    ds_write_b64 v35, v[52:53]
    v_add_u32 v35, v35, v37
    ds_write_b64 v35, v[52:53]
    v_add_u32 v35, v35, v37
    ds_write_b64 v35, v[52:53]
Lkz_71:
    s_mov_b64 exec, -1
    s_waitcnt lgkmcnt(0)
Liq_67:
    s_barrier
    s_add_u32 s75, s74, 8
    s_and_b32 s75, s75, 3
    s_mul_i32 s75, s75, 3
    s_mul_i32 s75, s75, 10240
    s_add_u32 s75, s75, s77
    s_add_u32 m0, s86, 90112
    s_nop 0
    buffer_load_dwordx4 v23, s[44:47], s75 offen offset:0 sc1 lds
    buffer_load_dwordx4 v23, s[44:47], s75 offen offset:1024 sc1 lds
    buffer_load_dwordx4 v23, s[44:47], s75 offen offset:2048 sc1 lds
    buffer_load_dwordx4 v23, s[44:47], s75 offen offset:3072 sc1 lds
    s_add_u32 m0, s86, 94208
    s_add_u32 s75, s75, 4096
    buffer_load_dwordx4 v23, s[44:47], s75 offen offset:0 sc1 lds
    buffer_load_dwordx4 v23, s[44:47], s75 offen offset:1024 sc1 lds
    buffer_load_dwordx4 v23, s[44:47], s75 offen offset:2048 sc1 lds
    buffer_load_dwordx4 v23, s[44:47], s75 offen offset:3072 sc1 lds
    s_add_u32 m0, s86, 98304
    s_add_u32 s75, s75, 4096
    buffer_load_dwordx4 v23, s[44:47], s75 offen offset:0 sc1 lds
    buffer_load_dwordx4 v23, s[44:47], s75 offen offset:1024 sc1 lds
    s_barrier
    s_add_u32 s75, s74, 9
    s_and_b32 s75, s75, 3
    s_mul_i32 s75, s75, 3
    s_mul_i32 s75, s75, 10240
    s_add_u32 s75, s75, s77
    s_add_u32 m0, s86, 110592
    s_nop 0
    buffer_load_dwordx4 v23, s[44:47], s75 offen offset:0 sc1 lds
    buffer_load_dwordx4 v23, s[44:47], s75 offen offset:1024 sc1 lds
    buffer_load_dwordx4 v23, s[44:47], s75 offen offset:2048 sc1 lds
    buffer_load_dwordx4 v23, s[44:47], s75 offen offset:3072 sc1 lds
    s_add_u32 m0, s86, 114688
    s_add_u32 s75, s75, 4096
    buffer_load_dwordx4 v23, s[44:47], s75 offen offset:0 sc1 lds
    buffer_load_dwordx4 v23, s[44:47], s75 offen offset:1024 sc1 lds
    buffer_load_dwordx4 v23, s[44:47], s75 offen offset:2048 sc1 lds
    buffer_load_dwordx4 v23, s[44:47], s75 offen offset:3072 sc1 lds
    s_add_u32 m0, s86, 118784
    s_add_u32 s75, s75, 4096
    buffer_load_dwordx4 v23, s[44:47], s75 offen offset:0 sc1 lds
    buffer_load_dwordx4 v23, s[44:47], s75 offen offset:1024 sc1 lds
    s_waitcnt vmcnt(30)
    s_barrier
    s_add_u32 s75, s74, 10
    s_and_b32 s75, s75, 3
    s_mul_i32 s75, s75, 3
    s_mul_i32 s75, s75, 10240
    s_add_u32 s75, s75, s77
    s_add_u32 m0, s86, 0
    s_nop 0
    buffer_load_dwordx4 v23, s[44:47], s75 offen offset:0 sc1 lds
    buffer_load_dwordx4 v23, s[44:47], s75 offen offset:1024 sc1 lds
    buffer_load_dwordx4 v23, s[44:47], s75 offen offset:2048 sc1 lds
    buffer_load_dwordx4 v23, s[44:47], s75 offen offset:3072 sc1 lds
    s_add_u32 m0, s86, 4096
    s_add_u32 s75, s75, 4096
    buffer_load_dwordx4 v23, s[44:47], s75 offen offset:0 sc1 lds
    buffer_load_dwordx4 v23, s[44:47], s75 offen offset:1024 sc1 lds
    buffer_load_dwordx4 v23, s[44:47], s75 offen offset:2048 sc1 lds
    buffer_load_dwordx4 v23, s[44:47], s75 offen offset:3072 sc1 lds
    s_add_u32 m0, s86, 8192
    s_add_u32 s75, s75, 4096
    buffer_load_dwordx4 v23, s[44:47], s75 offen offset:0 sc1 lds
    buffer_load_dwordx4 v23, s[44:47], s75 offen offset:1024 sc1 lds
    s_waitcnt vmcnt(30)
    s_barrier
    s_add_u32 s75, s74, 11
    s_and_b32 s75, s75, 3
    s_mul_i32 s75, s75, 3
    s_mul_i32 s75, s75, 10240
    s_add_u32 s75, s75, s77
    s_add_u32 m0, s86, 20480
    s_nop 0
    buffer_load_dwordx4 v23, s[44:47], s75 offen offset:0 sc1 lds
    buffer_load_dwordx4 v23, s[44:47], s75 offen offset:1024 sc1 lds
    buffer_load_dwordx4 v23, s[44:47], s75 offen offset:2048 sc1 lds
    buffer_load_dwordx4 v23, s[44:47], s75 offen offset:3072 sc1 lds
    s_add_u32 m0, s86, 24576
    s_add_u32 s75, s75, 4096
    buffer_load_dwordx4 v23, s[44:47], s75 offen offset:0 sc1 lds
    buffer_load_dwordx4 v23, s[44:47], s75 offen offset:1024 sc1 lds
    buffer_load_dwordx4 v23, s[44:47], s75 offen offset:2048 sc1 lds
    buffer_load_dwordx4 v23, s[44:47], s75 offen offset:3072 sc1 lds
    s_add_u32 m0, s86, 28672
    s_add_u32 s75, s75, 4096
    buffer_load_dwordx4 v23, s[44:47], s75 offen offset:0 sc1 lds
    buffer_load_dwordx4 v23, s[44:47], s75 offen offset:1024 sc1 lds
    s_waitcnt vmcnt(30)
    s_barrier
    s_add_u32 s75, s78, 0
    s_add_u32 m0, s86, 45056
    s_nop 0
    buffer_load_dwordx4 v23, s[44:47], s75 offen offset:0 sc1 lds
    buffer_load_dwordx4 v23, s[44:47], s75 offen offset:1024 sc1 lds
    buffer_load_dwordx4 v23, s[44:47], s75 offen offset:2048 sc1 lds
    buffer_load_dwordx4 v23, s[44:47], s75 offen offset:3072 sc1 lds
    s_add_u32 m0, s86, 49152
    s_add_u32 s75, s75, 4096
    buffer_load_dwordx4 v23, s[44:47], s75 offen offset:0 sc1 lds
    buffer_load_dwordx4 v23, s[44:47], s75 offen offset:1024 sc1 lds
    buffer_load_dwordx4 v23, s[44:47], s75 offen offset:2048 sc1 lds
    buffer_load_dwordx4 v23, s[44:47], s75 offen offset:3072 sc1 lds
    s_add_u32 m0, s86, 53248
    s_add_u32 s75, s75, 4096
    buffer_load_dwordx4 v23, s[44:47], s75 offen offset:0 sc1 lds
    buffer_load_dwordx4 v23, s[44:47], s75 offen offset:1024 sc1 lds
    s_waitcnt vmcnt(30)
    s_barrier
    s_add_u32 s75, s78, 10240
    s_add_u32 m0, s86, 65536
    s_nop 0
    buffer_load_dwordx4 v23, s[44:47], s75 offen offset:0 sc1 lds
    buffer_load_dwordx4 v23, s[44:47], s75 offen offset:1024 sc1 lds
    buffer_load_dwordx4 v23, s[44:47], s75 offen offset:2048 sc1 lds
    buffer_load_dwordx4 v23, s[44:47], s75 offen offset:3072 sc1 lds
    s_add_u32 m0, s86, 69632
    s_add_u32 s75, s75, 4096
    buffer_load_dwordx4 v23, s[44:47], s75 offen offset:0 sc1 lds
    buffer_load_dwordx4 v23, s[44:47], s75 offen offset:1024 sc1 lds
    buffer_load_dwordx4 v23, s[44:47], s75 offen offset:2048 sc1 lds
    buffer_load_dwordx4 v23, s[44:47], s75 offen offset:3072 sc1 lds
    s_add_u32 m0, s86, 73728
    s_add_u32 s75, s75, 4096
    buffer_load_dwordx4 v23, s[44:47], s75 offen offset:0 sc1 lds
    buffer_load_dwordx4 v23, s[44:47], s75 offen offset:1024 sc1 lds
    s_waitcnt vmcnt(30)
    s_barrier
    s_add_u32 s75, s78, 20480
    s_add_u32 m0, s86, 90112
    s_nop 0
    buffer_load_dwordx4 v23, s[44:47], s75 offen offset:0 sc1 lds
    buffer_load_dwordx4 v23, s[44:47], s75 offen offset:1024 sc1 lds
    buffer_load_dwordx4 v23, s[44:47], s75 offen offset:2048 sc1 lds
    buffer_load_dwordx4 v23, s[44:47], s75 offen offset:3072 sc1 lds
    s_add_u32 m0, s86, 94208
    s_add_u32 s75, s75, 4096
    buffer_load_dwordx4 v23, s[44:47], s75 offen offset:0 sc1 lds
    buffer_load_dwordx4 v23, s[44:47], s75 offen offset:1024 sc1 lds
    buffer_load_dwordx4 v23, s[44:47], s75 offen offset:2048 sc1 lds
    buffer_load_dwordx4 v23, s[44:47], s75 offen offset:3072 sc1 lds
    s_add_u32 m0, s86, 98304
    s_add_u32 s75, s75, 4096
    buffer_load_dwordx4 v23, s[44:47], s75 offen offset:0 sc1 lds
    buffer_load_dwordx4 v23, s[44:47], s75 offen offset:1024 sc1 lds
    s_waitcnt vmcnt(30)
    s_barrier
    s_add_u32 s75, s78, 30720
    s_add_u32 m0, s86, 110592
    s_nop 0
    buffer_load_dwordx4 v23, s[44:47], s75 offen offset:0 sc1 lds
    buffer_load_dwordx4 v23, s[44:47], s75 offen offset:1024 sc1 lds
    buffer_load_dwordx4 v23, s[44:47], s75 offen offset:2048 sc1 lds
    buffer_load_dwordx4 v23, s[44:47], s75 offen offset:3072 sc1 lds
    s_add_u32 m0, s86, 114688
    s_add_u32 s75, s75, 4096
    buffer_load_dwordx4 v23, s[44:47], s75 offen offset:0 sc1 lds
    buffer_load_dwordx4 v23, s[44:47], s75 offen offset:1024 sc1 lds
    buffer_load_dwordx4 v23, s[44:47], s75 offen offset:2048 sc1 lds
    buffer_load_dwordx4 v23, s[44:47], s75 offen offset:3072 sc1 lds
    s_add_u32 m0, s86, 118784
    s_add_u32 s75, s75, 4096
    buffer_load_dwordx4 v23, s[44:47], s75 offen offset:0 sc1 lds
    buffer_load_dwordx4 v23, s[44:47], s75 offen offset:1024 sc1 lds
    s_waitcnt vmcnt(30)
    s_barrier
    s_add_u32 s75, s78, 40960
    s_add_u32 m0, s86, 0
    s_nop 0
    buffer_load_dwordx4 v23, s[44:47], s75 offen offset:0 sc1 lds
    buffer_load_dwordx4 v23, s[44:47], s75 offen offset:1024 sc1 lds
    buffer_load_dwordx4 v23, s[44:47], s75 offen offset:2048 sc1 lds
    buffer_load_dwordx4 v23, s[44:47], s75 offen offset:3072 sc1 lds
    s_add_u32 m0, s86, 4096
    s_add_u32 s75, s75, 4096
    buffer_load_dwordx4 v23, s[44:47], s75 offen offset:0 sc1 lds
    buffer_load_dwordx4 v23, s[44:47], s75 offen offset:1024 sc1 lds
    buffer_load_dwordx4 v23, s[44:47], s75 offen offset:2048 sc1 lds
    buffer_load_dwordx4 v23, s[44:47], s75 offen offset:3072 sc1 lds
    s_add_u32 m0, s86, 8192
    s_add_u32 s75, s75, 4096
    buffer_load_dwordx4 v23, s[44:47], s75 offen offset:0 sc1 lds
    buffer_load_dwordx4 v23, s[44:47], s75 offen offset:1024 sc1 lds
    s_waitcnt vmcnt(30)
    s_barrier
    s_mov_b32 s52, s20
    s_and_b32 s53, s21, 0xffff
    s_mov_b32 s54, 0x280000
    s_mov_b32 s55, 0x20000
    v_add_u32 v12, 0, v0
    v_mul_u32_u24 v165, 6554, v12
    v_lshrrev_b32 v165, 16, v165
    v_lshlrev_b32 v164, 4, v12
    v_mad_u32_u24 v13, v165, 8, v164
    v_mul_u32_u24 v165, 1120, v165
    v_add_u32 v165, v165, v164
    v_add_u32 v164, 145408, v13
    v_add_u32 v12, 256, v0
    v_mul_u32_u24 v163, 6554, v12
    v_lshrrev_b32 v163, 16, v163
    v_lshlrev_b32 v162, 4, v12
    v_mad_u32_u24 v13, v163, 8, v162
    v_mul_u32_u24 v163, 1120, v163
    v_add_u32 v163, v163, v162
    v_add_u32 v162, 145408, v13
    s_mul_i32 s83, s64, 81920
    s_mul_i32 s71, s65, 160
    s_add_u32 s83, s83, s71
    s_waitcnt vmcnt(0)
    s_barrier
    s_barrier
    s_barrier
    s_cmp_ge_u32 s60, 2
    s_cbranch_scc1 Llf_72
    ds_read_b64 v[12:13], v162
    ds_read_b64 v[14:15], v162 offset:8
    s_waitcnt lgkmcnt(0)
    buffer_store_dwordx4 v[12:15], v163, s[52:55], s83 offen
Llf_72:
    ds_read_b64 v[4:5], v164
    ds_read_b64 v[6:7], v164 offset:8
    s_waitcnt lgkmcnt(0)
    buffer_store_dwordx4 v[4:7], v165, s[52:55], s83 offen
    s_endpgm
Lcompute:
    s_sub_u32 s70, s60, 4
    s_and_b32 s68, s70, 1
    s_lshr_b32 s69, s70, 1
    v_add_u32 v0, 4294967040, v0
    v_and_b32 v248, 15, v1
    v_lshrrev_b32 v249, 4, v1
    v_lshrrev_b32 v126, 1, v248
    v_xor_b32 v126, v126, v249
    v_lshlrev_b32 v126, 4, v126
    v_lshl_add_u32 v126, v248, 7, v126
    s_lshl_b32 s70, s68, 13
    s_lshl_b32 s71, s69, 12
    s_add_u32 s70, s70, s71
    v_add_u32 v2, s70, v126
    v_xor_b32 v3, 64, v2
    v_xor_b32 v4, 4096, v2
    v_xor_b32 v5, 64, v4
    s_lshr_b32 s70, s70, 5
    s_add_u32 s70, s70, 86016
    v_lshl_add_u32 v251, v248, 2, s70
    v_bfe_u32 v127, v1, 2, 3
    v_lshrrev_b32 v128, 5, v1
    v_lshl_add_u32 v128, v128, 4, v127
    v_and_b32 v129, 3, v1
    v_lshlrev_b32 v130, 3, v129
    v_mul_u32_u24 v6, 160, v128
    s_mul_i32 s70, s69, 80
    s_add_u32 s70, s70, 16384
    v_add3_u32 v6, v6, v130, s70
    v_mov_b32 v12, 0
    v_mov_b32 v13, 0
    v_mov_b32 v14, 0
    v_mov_b32 v15, 0
    v_mov_b32 v16, 0
    v_mov_b32 v17, 0
    v_mov_b32 v18, 0
    v_mov_b32 v19, 0
    v_mov_b32 v20, 0
    v_mov_b32 v21, 0
    v_mov_b32 v22, 0
    v_mov_b32 v23, 0
    v_mov_b32 v24, 0
    v_mov_b32 v25, 0
    v_mov_b32 v26, 0
    v_mov_b32 v27, 0
    v_mov_b32 v28, 0
    v_mov_b32 v29, 0
    v_mov_b32 v30, 0
    v_mov_b32 v31, 0
    v_mov_b32 v32, 0
    v_mov_b32 v33, 0
    v_mov_b32 v34, 0
    v_mov_b32 v35, 0
    v_mov_b32 v36, 0
    v_mov_b32 v37, 0
    v_mov_b32 v38, 0
    v_mov_b32 v39, 0
    v_mov_b32 v40, 0
    v_mov_b32 v41, 0
    v_mov_b32 v42, 0
    v_mov_b32 v43, 0
    v_mov_b32 v44, 0
    v_mov_b32 v45, 0
    v_mov_b32 v46, 0
    v_mov_b32 v47, 0
    v_mov_b32 v48, 0
    v_mov_b32 v49, 0
    v_mov_b32 v50, 0
    v_mov_b32 v51, 0
    v_mov_b32 v52, 0
    v_mov_b32 v53, 0
    v_mov_b32 v54, 0
    v_mov_b32 v55, 0
    v_mov_b32 v56, 0
    v_mov_b32 v57, 0
    v_mov_b32 v58, 0
    v_mov_b32 v59, 0
    v_mov_b32 v60, 0
    v_mov_b32 v61, 0
    v_mov_b32 v62, 0
    v_mov_b32 v63, 0
    v_mov_b32 v64, 0
    v_mov_b32 v65, 0
    v_mov_b32 v66, 0
    v_mov_b32 v67, 0
    v_mov_b32 v68, 0
    v_mov_b32 v69, 0
    v_mov_b32 v70, 0
    v_mov_b32 v71, 0
    v_mov_b32 v72, 0
    v_mov_b32 v73, 0
    v_mov_b32 v74, 0
    v_mov_b32 v75, 0
    v_mov_b32 v76, 0
    v_mov_b32 v77, 0
    v_mov_b32 v78, 0
    v_mov_b32 v79, 0
    v_mov_b32 v80, 0
    v_mov_b32 v81, 0
    v_mov_b32 v82, 0
    v_mov_b32 v83, 0
    v_mov_b32 v84, 0
    v_mov_b32 v85, 0
    v_mov_b32 v86, 0
    v_mov_b32 v87, 0
    v_mov_b32 v88, 0
    v_mov_b32 v89, 0
    v_mov_b32 v90, 0
    v_mov_b32 v91, 0
    v_mov_b32 v92, 0
    v_mov_b32 v93, 0
    v_mov_b32 v94, 0
    v_mov_b32 v95, 0
    v_mov_b32 v96, 0
    v_mov_b32 v97, 0
    v_mov_b32 v98, 0
    v_mov_b32 v99, 0
    v_mov_b32 v100, 0
    v_mov_b32 v101, 0
    v_mov_b32 v102, 0
    v_mov_b32 v103, 0
    v_mov_b32 v104, 0
    v_mov_b32 v105, 0
    v_mov_b32 v106, 0
    v_mov_b32 v107, 0
    v_mov_b32 v108, 0
    v_mov_b32 v109, 0
    v_mov_b32 v110, 0
    v_mov_b32 v111, 0
    v_mov_b32 v112, 0
    v_mov_b32 v113, 0
    v_mov_b32 v114, 0
    v_mov_b32 v115, 0
    v_mov_b32 v116, 0
    v_mov_b32 v117, 0
    v_mov_b32 v118, 0
    v_mov_b32 v119, 0
    v_mov_b32 v120, 0
    v_mov_b32 v121, 0
    v_mov_b32 v122, 0
    v_mov_b32 v123, 0
    v_mov_b32 v212, 0x3f803f80
    v_mov_b32 v213, 0x3f803f80
    v_mov_b32 v214, 0x3f803f80
    v_mov_b32 v215, 0x3f803f80
    s_mov_b32 s83, 0
    s_lshr_b32 s70, s66, 1
    s_lshl_b32 s70, s70, 3
    s_and_b32 s71, s67, 7
    s_add_u32 s64, s70, s71
    s_and_b32 s70, s66, 1
    s_lshl_b32 s70, s70, 2
    s_lshr_b32 s71, s67, 3
    s_add_u32 s65, s70, s71
    s_add_u32 s81, s62, 128
    s_cmp_lt_u32 s61, 4
    s_cselect_b32 s81, s81, 255
    s_lshl_b32 s70, s62, 4
    s_add_u32 s70, s70, s61
    s_cmp_eq_u32 s63, 1
    s_cselect_b32 s81, s70, s81
    s_waitcnt lgkmcnt(0)
    s_mov_b32 s44, s24
    s_and_b32 s45, s25, 0xffff
    s_mov_b32 s46, 0xf00000
    s_mov_b32 s47, 0x20000
    s_cmp_gt_u32 s81, 135
    s_cselect_b32 s70, 0, s81
    s_lshr_b32 s70, s70, 1
    s_cmp_lt_u32 s70, 48
    s_cselect_b32 s48, s16, s8
    s_cselect_b32 s49, s17, s9
    s_mov_b32 s50, 0xc8000
    s_cselect_b32 s50, 0x1e0000, s50
    s_mov_b32 s51, 0x20000
    s_cbranch_scc1 Lpkm_73
    s_sub_u32 s73, s70, 48
    s_mul_i32 s71, s73, 52
    s_lshr_b32 s71, s71, 8
    s_mul_i32 s72, s71, 5
    s_sub_u32 s73, s73, s72
    s_mul_i32 s71, s71, 160
    s_lshl_b32 s72, s73, 5
    s_cmp_ge_u32 s73, 2
    s_cselect_b32 s70, 16, 0
    s_add_u32 s72, s72, s70
    s_cmp_eq_u32 s73, 4
    s_cselect_b32 s72, 64, s72
    s_cselect_b32 s70, 81920, 0
    s_add_u32 s71, s71, s72
    s_branch Lpkd_74
Lpkm_73:
    s_mul_i32 s71, s70, 43
    s_lshr_b32 s71, s71, 8
    s_mul_i32 s71, s71, 6
    s_sub_u32 s71, s70, s71
    s_cmp_eq_u32 s71, 3
    s_cselect_b32 s72, 1, 0
    s_cmp_eq_u32 s71, 4
    s_cselect_b32 s72, -1, s72
    s_add_u32 s70, s70, s72
    s_lshl_b32 s71, s70, 5
    s_mov_b32 s70, 0
Lpkd_74:
    s_and_b32 s49, s49, 0xffff
    s_cmp_ge_u32 s60, 6
    s_cselect_b32 s70, s70, 0
    s_lshl_b32 s72, s60, 3
    s_add_u32 s71, s71, s72
    s_sub_u32 s71, s71, 32
    s_mul_i32 s71, s71, 1280
    s_add_u32 s71, s71, s70
    s_and_b32 s72, s81, 1
    s_mul_i32 s73, s72, 640
    s_add_u32 s100, s71, s73
    v_mov_b32 v145, 0x40000000
    s_mul_i32 s72, s61, 160
    s_cmp_eq_u32 s63, 1
    s_cselect_b32 s72, 0, s72
    s_movk_i32 s73, 160
    s_cselect_b32 s73, 640, s73
    v_add_u32 v141, 0, v1
    v_mul_u32_u24 v142, 1639, v141
    v_lshrrev_b32 v142, 16, v142
    v_mul_u32_u24 v142, 640, v142
    v_lshlrev_b32 v141, 4, v141
    v_sub_u32 v144, v141, v142
    v_add_u32 v142, v142, v141
    v_subrev_u32 v144, s72, v144
    v_cmp_gt_u32 vcc, s73, v144
    s_nop 1
    v_cndmask_b32 v250, v145, v142, vcc
    v_add_u32 v141, 64, v1
    v_mul_u32_u24 v142, 1639, v141
    v_lshrrev_b32 v142, 16, v142
    v_mul_u32_u24 v142, 640, v142
    v_lshlrev_b32 v141, 4, v141
    v_sub_u32 v144, v141, v142
    v_add_u32 v142, v142, v141
    v_subrev_u32 v144, s72, v144
    v_cmp_gt_u32 vcc, s73, v144
    s_nop 1
    v_cndmask_b32 v252, v145, v142, vcc
    v_add_u32 v141, 128, v1
    v_mul_u32_u24 v142, 1639, v141
    v_lshrrev_b32 v142, 16, v142
    v_mul_u32_u24 v142, 640, v142
    v_lshlrev_b32 v141, 4, v141
    v_sub_u32 v144, v141, v142
    v_add_u32 v142, v142, v141
    v_subrev_u32 v144, s72, v144
    v_cmp_gt_u32 vcc, s73, v144
    s_nop 1
    v_cndmask_b32 v253, v145, v142, vcc
    v_add_u32 v141, 192, v1
    v_mul_u32_u24 v142, 1639, v141
    v_lshrrev_b32 v142, 16, v142
    v_mul_u32_u24 v142, 640, v142
    v_lshlrev_b32 v141, 4, v141
    v_sub_u32 v144, v141, v142
    v_add_u32 v142, v142, v141
    v_subrev_u32 v144, s72, v144
    v_cmp_gt_u32 vcc, s73, v144
    s_nop 1
    v_cndmask_b32 v254, v145, v142, vcc
    v_add_u32 v141, 256, v1
    v_mul_u32_u24 v142, 1639, v141
    v_lshrrev_b32 v142, 16, v142
    v_mul_u32_u24 v142, 640, v142
    v_lshlrev_b32 v141, 4, v141
    v_sub_u32 v144, v141, v142
    v_add_u32 v142, v142, v141
    v_subrev_u32 v144, s72, v144
    v_cmp_gt_u32 vcc, s73, v144
    s_nop 1
    v_cndmask_b32 v255, v145, v142, vcc
    s_lshl_b32 s72, s64, 2
    s_lshl_b32 s73, s68, 1
    s_add_u32 s72, s72, s73
    s_add_u32 s72, s72, s69
    s_xor_b32 s73, s72, 1
    s_mul_i32 s78, s72, 49152
    s_mul_i32 s70, s69, 24576
    s_add_u32 s78, s78, s70
    s_add_u32 s78, s78, 8388608
    s_mul_i32 s79, s72, 20480
    s_mul_i32 s70, s69, 10240
    s_add_u32 s79, s79, s70
    s_add_u32 s79, s79, 5242880
    s_mul_i32 s66, s73, 49152
    s_mul_i32 s70, s69, 24576
    s_add_u32 s66, s66, s70
    s_add_u32 s66, s66, 8388608
    s_mul_i32 s3, s73, 20480
    s_mul_i32 s70, s69, 10240
    s_add_u32 s3, s3, s70
    s_add_u32 s3, s3, 5242880
    s_lshr_b32 s71, s67, 3
    s_mul_i32 s74, s71, 0
    s_and_b32 s71, s67, 7
    s_mul_i32 s71, s71, 1
    s_add_u32 s74, s74, s71
    s_mul_i32 s70, s61, 10
    s_add_u32 s70, s70, s26
    s_lshl_b32 s70, s70, 10
    s_add_u32 s8, s70, 4294926336
    s_mul_i32 s70, s27, 10
    s_add_u32 s70, s70, s26
    s_lshl_b32 s70, s70, 10
    s_mul_i32 s71, s69, 448
    s_add_u32 s70, s70, s71
    s_lshl_b32 s71, s68, 8
    s_add_u32 s70, s70, s71
    s_add_u32 s9, s70, 294912
    s_min_u32 s70, s61, s27
    s_cmp_lt_u32 s70, 10
    s_cselect_b32 s10, 2, 0
    s_cselect_b32 s11, 6, 0
    s_cmp_le_u32 s81, 135
    s_cselect_b32 s70, 10, 0
    s_cselect_b32 s71, 16, 0
    s_or_b32 s10, s10, s70
    s_or_b32 s11, s11, s71
    s_cmp_lg_u32 s63, 0
    s_cbranch_scc1 Lc_q
    s_lshl_b32 s70, s61, 3
    s_lshl_b32 s71, s68, 2
    s_add_u32 s70, s70, s71
    s_lshl_b32 s71, s69, 1
    s_add_u32 s70, s70, s71
    s_xor_b32 s71, s70, 2
    s_mul_i32 s72, s62, 6
    s_add_u32 s72, s72, s69
    s_add_u32 s72, s72, 8192
    s_mul_i32 s70, s70, 48
    s_add_u32 s70, s70, s72
    s_lshl_b32 s76, s70, 10
    s_mul_i32 s71, s71, 48
    s_add_u32 s71, s71, s72
    s_lshl_b32 s77, s71, 10
    s_lshl_b32 s70, s62, 4
    s_add_u32 s70, s70, s61
    s_mul_i32 s70, s70, 6784
    s_add_u32 s80, s70, 524288
    s_mul_i32 s70, s68, 6720
    s_mul_i32 s71, s69, 3360
    s_add_u32 s70, s70, s71
    s_add_u32 s75, s70, 135168
    v_cmp_gt_u32 vcc, 2, v129
    v_mov_b32 v131, 10224
    s_nop 0
    v_cndmask_b32 v131, v131, 64, vcc
    v_add_u32 v7, v6, v131
    v_lshrrev_b32 v131, 1, v127
    v_lshl_add_u32 v132, v128, 7, v130
    v_add_u32 v132, 36864, v132
    s_lshl_b32 s70, s69, 1
    v_xor_b32 v131, s70, v131
    v_lshl_add_u32 v8, v131, 5, v132
    v_xor_b32 v131, 1, v131
    v_lshl_add_u32 v9, v131, 5, v132
    s_branch Lp1_0
Lc_q:
    s_lshl_b32 s70, s61, 3
    s_lshl_b32 s71, s68, 2
    s_add_u32 s70, s70, s71
    s_lshl_b32 s71, s69, 1
    s_add_u32 s70, s70, s71
    s_xor_b32 s71, s70, 2
    s_mul_i32 s72, s62, 6
    s_add_u32 s72, s72, s69
    s_add_u32 s72, s72, 8194
    s_mul_i32 s70, s70, 48
    s_add_u32 s70, s70, s72
    s_lshl_b32 s76, s70, 10
    s_mul_i32 s71, s71, 48
    s_add_u32 s71, s71, s72
    s_lshl_b32 s77, s71, 10
    v_lshl_add_u32 v132, v128, 8, v130
    v_add_u32 v132, 26624, v132
    s_lshl_b32 s70, s69, 2
    v_xor_b32 v131, s70, v127
    v_xor_b32 v133, 0, v131
    v_lshl_add_u32 v7, v133, 5, v132
    v_xor_b32 v133, 1, v131
    v_lshl_add_u32 v8, v133, 5, v132
    v_xor_b32 v133, 2, v131
    v_lshl_add_u32 v9, v133, 5, v132
    v_xor_b32 v133, 3, v131
    v_lshl_add_u32 v10, v133, 5, v132
    s_branch Lp1_1
Lduty0:
    v_mfma_f32_16x16x32_bf16 v[216:219], v[212:215], v[124:127], 0
    v_mfma_f32_16x16x32_bf16 v[224:227], v[124:127], v[124:127], 0
    v_mfma_f32_16x16x32_bf16 v[220:223], v[212:215], v[128:131], 0
    v_mfma_f32_16x16x32_bf16 v[228:231], v[128:131], v[128:131], 0
    s_cmp_lg_u32 s68, 0
    s_cbranch_scc1 Ldr_75
    v_mfma_f32_16x16x32_bf16 v[232:235], v[212:215], v[140:143], 0
    v_mfma_f32_16x16x32_bf16 v[236:239], v[212:215], v[144:147], 0
    v_mfma_f32_16x16x32_bf16 v[240:243], v[212:215], v[148:151], 0
    v_mfma_f32_16x16x32_bf16 v[244:247], v[212:215], v[152:155], 0
    s_branch Ldd_76
Ldr_75:
    v_mfma_f32_16x16x32_bf16 v[232:235], v[212:215], v[156:159], 0
    v_mfma_f32_16x16x32_bf16 v[236:239], v[212:215], v[160:163], 0
    v_mfma_f32_16x16x32_bf16 v[240:243], v[212:215], v[164:167], 0
Ldd_76:
    s_cmp_lg_u32 s63, 0
    s_cbranch_scc1 Lret0_1
    s_branch Lret0_0
Lduty1:
    v_mfma_f32_16x16x32_bf16 v[216:219], v[212:215], v[168:171], v[216:219]
    v_mfma_f32_16x16x32_bf16 v[224:227], v[168:171], v[168:171], v[224:227]
    v_mfma_f32_16x16x32_bf16 v[220:223], v[212:215], v[172:175], v[220:223]
    v_mfma_f32_16x16x32_bf16 v[228:231], v[172:175], v[172:175], v[228:231]
    s_cmp_lg_u32 s68, 0
    s_cbranch_scc1 Ldr_77
    v_mfma_f32_16x16x32_bf16 v[232:235], v[212:215], v[184:187], v[232:235]
    v_mfma_f32_16x16x32_bf16 v[236:239], v[212:215], v[188:191], v[236:239]
    v_mfma_f32_16x16x32_bf16 v[240:243], v[212:215], v[192:195], v[240:243]
    v_mfma_f32_16x16x32_bf16 v[244:247], v[212:215], v[196:199], v[244:247]
    s_branch Ldd_78
Ldr_77:
    v_mfma_f32_16x16x32_bf16 v[232:235], v[212:215], v[200:203], v[232:235]
    v_mfma_f32_16x16x32_bf16 v[236:239], v[212:215], v[204:207], v[236:239]
    v_mfma_f32_16x16x32_bf16 v[240:243], v[212:215], v[208:211], v[240:243]
Ldd_78:
    s_cmp_lg_u32 s63, 0
    s_cbranch_scc1 Lret1_1
    s_branch Lret1_0
Lx1:
    s_cmp_lg_u32 s83, 1
    s_cbranch_scc1 Lp3_79
    s_cmp_gt_u32 s81, 135
    s_cbranch_scc1 Lpd_81
    s_mul_i32 s70, s60, 5120
    s_add_u32 m0, s70, 114688
    s_nop 0
    buffer_load_dwordx4 v250, s[48:51], s100 offen lds
    s_add_u32 m0, s70, 115712
    s_nop 0
    buffer_load_dwordx4 v252, s[48:51], s100 offen lds
    s_add_u32 m0, s70, 116736
    s_nop 0
    buffer_load_dwordx4 v253, s[48:51], s100 offen lds
    s_add_u32 m0, s70, 117760
    s_nop 0
    buffer_load_dwordx4 v254, s[48:51], s100 offen lds
    s_add_u32 m0, s70, 118784
    s_nop 0
    buffer_load_dwordx4 v255, s[48:51], s100 offen lds
Lpd_81:
    s_branch Lduty1
Lp3_79:
    s_cmp_gt_u32 s81, 135
    s_cbranch_scc1 Lpa_80
    v_lshrrev_b32 v252, 2, v1
    v_mul_u32_u24 v252, 640, v252
    v_and_b32 v253, 3, v1
    v_lshl_add_u32 v252, v253, 3, v252
    s_mul_i32 s70, s60, 160
    s_add_u32 s70, s70, 134528
    v_add_u32 v252, s70, v252
    ds_read_b64_tr_b16 v[216:217], v252 offset:0
    ds_read_b64_tr_b16 v[218:219], v252 offset:10240
    ds_read_b64_tr_b16 v[220:221], v252 offset:32
    ds_read_b64_tr_b16 v[222:223], v252 offset:10272
    ds_read_b64_tr_b16 v[224:225], v252 offset:64
    ds_read_b64_tr_b16 v[226:227], v252 offset:10304
    ds_read_b64_tr_b16 v[228:229], v252 offset:96
    ds_read_b64_tr_b16 v[230:231], v252 offset:10336
    ds_read_b64_tr_b16 v[232:233], v252 offset:128
    ds_read_b64_tr_b16 v[234:235], v252 offset:10368
Lpa_80:
    s_cmp_lg_u32 s63, 0
    s_cbranch_scc1 Lret1_1
    s_branch Lret1_0
Lx0:
    s_waitcnt lgkmcnt(0)
    s_cmp_lg_u32 s83, 1
    s_cbranch_scc1 Lp1_84
    s_branch Lduty0
Lp1_84:
    s_cmp_lg_u32 s83, 2
    s_cbranch_scc1 Lps_83
    v_and_b32 v252, 3, v1
    v_lshl_add_u32 v218, v251, 1, s8
    v_lshl_add_u32 v219, v248, 2, s9
    v_cmp_eq_u32 vcc, 1, v252
    s_nop 1
    v_cndmask_b32 v217, v224, v225, vcc
    v_cndmask_b32 v221, v228, v229, vcc
    v_cmp_eq_u32 vcc, 2, v252
    s_nop 1
    v_cndmask_b32 v217, v217, v226, vcc
    v_cndmask_b32 v221, v221, v230, vcc
    v_cmp_eq_u32 vcc, 3, v252
    s_nop 1
    v_cndmask_b32 v217, v217, v227, vcc
    v_cndmask_b32 v221, v221, v231, vcc
    s_cmp_ge_u32 s27, 10
    s_cbranch_scc1 Ldn_85
    s_mov_b32 exec_lo, 0xf0000f
    s_mov_b32 exec_hi, 0xf0000f00
    buffer_store_dwordx2 v[216:217], v218, s[44:47], 0 offen offset:0 sc1
    buffer_store_dwordx2 v[220:221], v218, s[44:47], 0 offen offset:128 sc1
Ldn_85:
    s_cmp_ge_u32 s61, 10
    s_cbranch_scc1 Ldn_86
    s_mov_b32 exec_lo, 0xffff
    s_mov_b32 exec_hi, 0x0
    buffer_store_dword v232, v219, s[44:47], 0 offen offset:0 sc1
    buffer_store_dword v236, v219, s[44:47], 0 offen offset:64 sc1
    buffer_store_dword v240, v219, s[44:47], 0 offen offset:128 sc1
    s_cmp_lg_u32 s68, 0
    s_cbranch_scc1 Ldn_86
    buffer_store_dword v244, v219, s[44:47], 0 offen offset:192 sc1
Ldn_86:
    s_mov_b64 exec, -1
    s_branch Lpb_82
Lps_83:
    s_sub_u32 s72, s60, 4
    s_cmp_eq_u32 s63, 1
    s_cselect_b32 s70, s72, s61
    s_cmp_lg_u32 s70, s72
    s_cbranch_scc1 Lpb_82
    s_and_b32 s70, s81, 1
    s_lshl_b32 s70, s70, 2
    s_add_u32 s70, s70, s72
    s_mul_i32 s70, s70, 68
    s_lshr_b32 s71, s81, 1
    s_add_u32 s70, s70, s71
    s_mul_i32 s70, s70, 5120
    s_add_u32 s70, s70, 2097152
    s_add_u32 s71, s70, 4096
    v_lshlrev_b32 v252, 4, v1
    buffer_store_dwordx4 v[216:219], v252, s[44:47], s70 offen offset:0 sc1
    buffer_store_dwordx4 v[220:223], v252, s[44:47], s70 offen offset:1024 sc1
    buffer_store_dwordx4 v[224:227], v252, s[44:47], s70 offen offset:2048 sc1
    buffer_store_dwordx4 v[228:231], v252, s[44:47], s70 offen offset:3072 sc1
    buffer_store_dwordx4 v[232:235], v252, s[44:47], s71 offen sc1
Lpb_82:
    s_cmp_lg_u32 s63, 0
    s_cbranch_scc1 Lret0_1
    s_branch Lret0_0
Lp1_0:
    s_mov_b32 s86, 0xfffea000
    s_mov_b32 s87, 45056
    s_barrier
    ds_read_b128 v[124:127], v2 offset:0
    ds_read_b128 v[128:131], v2 offset:2048
    ds_read_b128 v[132:135], v4 offset:0
    ds_read_b128 v[136:139], v4 offset:2048
    ds_read_b64_tr_b16 v[140:141], v6 offset:0
    ds_read_b64_tr_b16 v[142:143], v6 offset:1280
    ds_read_b64_tr_b16 v[144:145], v6 offset:32
    ds_read_b64_tr_b16 v[146:147], v6 offset:1312
    ds_read_b64_tr_b16 v[148:149], v7 offset:0
    ds_read_b64_tr_b16 v[150:151], v7 offset:1280
    ds_read_b64_tr_b16 v[152:153], v6 offset:10256
    ds_read_b64_tr_b16 v[154:155], v6 offset:11536
    ds_read_b64_tr_b16 v[156:157], v6 offset:10288
    ds_read_b64_tr_b16 v[158:159], v6 offset:11568
    ds_read_b64_tr_b16 v[160:161], v8 offset:0
    ds_read_b64_tr_b16 v[162:163], v8 offset:1024
    ds_read_b64_tr_b16 v[164:165], v9 offset:0
    ds_read_b64_tr_b16 v[166:167], v9 offset:1024
    s_waitcnt lgkmcnt(0)
    s_branch Lret1_0
.p2align 3
Lp1h_0_1:
    s_barrier
    v_mfma_f32_16x16x32_bf16 v[12:15], v[168:171], v[184:187], v[12:15]
    v_mfma_f32_16x16x32_bf16 v[16:19], v[172:175], v[184:187], v[16:19]
    v_mfma_f32_16x16x32_bf16 v[20:23], v[176:179], v[184:187], v[20:23]
    ds_read_b128 v[124:127], v2 offset:0
    v_mfma_f32_16x16x32_bf16 v[24:27], v[180:183], v[184:187], v[24:27]
    ds_read_b128 v[128:131], v2 offset:2048
    v_mfma_f32_16x16x32_bf16 v[28:31], v[168:171], v[188:191], v[28:31]
    ds_read_b128 v[132:135], v4 offset:0
    v_mfma_f32_16x16x32_bf16 v[32:35], v[172:175], v[188:191], v[32:35]
    ds_read_b128 v[136:139], v4 offset:2048
    v_mfma_f32_16x16x32_bf16 v[36:39], v[176:179], v[188:191], v[36:39]
    ds_read_b64_tr_b16 v[140:141], v6 offset:0
    v_mfma_f32_16x16x32_bf16 v[40:43], v[180:183], v[188:191], v[40:43]
    ds_read_b64_tr_b16 v[142:143], v6 offset:1280
    v_mfma_f32_16x16x32_bf16 v[44:47], v[168:171], v[192:195], v[44:47]
    ds_read_b64_tr_b16 v[144:145], v6 offset:32
    v_mfma_f32_16x16x32_bf16 v[48:51], v[172:175], v[192:195], v[48:51]
    ds_read_b64_tr_b16 v[146:147], v6 offset:1312
    v_mfma_f32_16x16x32_bf16 v[52:55], v[176:179], v[192:195], v[52:55]
    ds_read_b64_tr_b16 v[148:149], v7 offset:0
    v_mfma_f32_16x16x32_bf16 v[56:59], v[180:183], v[192:195], v[56:59]
    ds_read_b64_tr_b16 v[150:151], v7 offset:1280
    v_mfma_f32_16x16x32_bf16 v[60:63], v[168:171], v[196:199], v[60:63]
    ds_read_b64_tr_b16 v[152:153], v6 offset:10256
    v_mfma_f32_16x16x32_bf16 v[64:67], v[172:175], v[196:199], v[64:67]
    ds_read_b64_tr_b16 v[154:155], v6 offset:11536
    v_mfma_f32_16x16x32_bf16 v[68:71], v[176:179], v[196:199], v[68:71]
    ds_read_b64_tr_b16 v[156:157], v6 offset:10288
    v_mfma_f32_16x16x32_bf16 v[72:75], v[180:183], v[196:199], v[72:75]
    ds_read_b64_tr_b16 v[158:159], v6 offset:11568
    v_mfma_f32_16x16x32_bf16 v[76:79], v[168:171], v[200:203], v[76:79]
    ds_read_b64_tr_b16 v[160:161], v8 offset:0
    v_mfma_f32_16x16x32_bf16 v[80:83], v[172:175], v[200:203], v[80:83]
    ds_read_b64_tr_b16 v[162:163], v8 offset:1024
    v_mfma_f32_16x16x32_bf16 v[84:87], v[176:179], v[200:203], v[84:87]
    ds_read_b64_tr_b16 v[164:165], v9 offset:0
    v_mfma_f32_16x16x32_bf16 v[88:91], v[180:183], v[200:203], v[88:91]
    ds_read_b64_tr_b16 v[166:167], v9 offset:1024
    v_mfma_f32_16x16x32_bf16 v[92:95], v[204:207], v[168:171], v[92:95]
    v_mfma_f32_16x16x32_bf16 v[96:99], v[204:207], v[172:175], v[96:99]
    v_mfma_f32_16x16x32_bf16 v[100:103], v[204:207], v[176:179], v[100:103]
    v_mfma_f32_16x16x32_bf16 v[104:107], v[204:207], v[180:183], v[104:107]
    v_mfma_f32_16x16x32_bf16 v[108:111], v[208:211], v[168:171], v[108:111]
    v_mfma_f32_16x16x32_bf16 v[112:115], v[208:211], v[172:175], v[112:115]
    s_bitcmp1_b32 s10, s83
    v_mfma_f32_16x16x32_bf16 v[116:119], v[208:211], v[176:179], v[116:119]
    v_mfma_f32_16x16x32_bf16 v[120:123], v[208:211], v[180:183], v[120:123]
    s_cbranch_scc1 Lx1
Lret1_0:
    s_waitcnt lgkmcnt(0)
    v_mfma_f32_16x16x32_bf16 v[12:15], v[124:127], v[140:143], v[12:15]
    s_add_u32 s83, s83, 1
    ds_read_b128 v[168:171], v3 offset:0
    v_mfma_f32_16x16x32_bf16 v[16:19], v[128:131], v[140:143], v[16:19]
    s_bitcmp1_b32 0x248, s83
    ds_read_b128 v[172:175], v3 offset:2048
    v_mfma_f32_16x16x32_bf16 v[20:23], v[132:135], v[140:143], v[20:23]
    s_cselect_b32 s82, s86, s87
    ds_read_b128 v[176:179], v5 offset:0
    v_mfma_f32_16x16x32_bf16 v[24:27], v[136:139], v[140:143], v[24:27]
    ds_read_b128 v[180:183], v5 offset:2048
    v_mfma_f32_16x16x32_bf16 v[28:31], v[124:127], v[144:147], v[28:31]
    ds_read_b64_tr_b16 v[184:185], v6 offset:5120
    v_mfma_f32_16x16x32_bf16 v[32:35], v[128:131], v[144:147], v[32:35]
    ds_read_b64_tr_b16 v[186:187], v6 offset:6400
    v_mfma_f32_16x16x32_bf16 v[36:39], v[132:135], v[144:147], v[36:39]
    ds_read_b64_tr_b16 v[188:189], v6 offset:5152
    v_mfma_f32_16x16x32_bf16 v[40:43], v[136:139], v[144:147], v[40:43]
    ds_read_b64_tr_b16 v[190:191], v6 offset:6432
    v_mfma_f32_16x16x32_bf16 v[44:47], v[124:127], v[148:151], v[44:47]
    ds_read_b64_tr_b16 v[192:193], v7 offset:5120
    v_mfma_f32_16x16x32_bf16 v[48:51], v[128:131], v[148:151], v[48:51]
    ds_read_b64_tr_b16 v[194:195], v7 offset:6400
    v_mfma_f32_16x16x32_bf16 v[52:55], v[132:135], v[148:151], v[52:55]
    ds_read_b64_tr_b16 v[196:197], v6 offset:15376
    v_mfma_f32_16x16x32_bf16 v[56:59], v[136:139], v[148:151], v[56:59]
    ds_read_b64_tr_b16 v[198:199], v6 offset:16656
    v_mfma_f32_16x16x32_bf16 v[60:63], v[124:127], v[152:155], v[60:63]
    ds_read_b64_tr_b16 v[200:201], v6 offset:15408
    v_mfma_f32_16x16x32_bf16 v[64:67], v[128:131], v[152:155], v[64:67]
    ds_read_b64_tr_b16 v[202:203], v6 offset:16688
    v_mfma_f32_16x16x32_bf16 v[68:71], v[132:135], v[152:155], v[68:71]
    ds_read_b64_tr_b16 v[204:205], v8 offset:4096
    v_mfma_f32_16x16x32_bf16 v[72:75], v[136:139], v[152:155], v[72:75]
    ds_read_b64_tr_b16 v[206:207], v8 offset:5120
    v_mfma_f32_16x16x32_bf16 v[76:79], v[124:127], v[156:159], v[76:79]
    ds_read_b64_tr_b16 v[208:209], v9 offset:4096
    v_mfma_f32_16x16x32_bf16 v[80:83], v[128:131], v[156:159], v[80:83]
    ds_read_b64_tr_b16 v[210:211], v9 offset:5120
    v_mfma_f32_16x16x32_bf16 v[84:87], v[132:135], v[156:159], v[84:87]
    v_add_u32 v2, s82, v2
    v_add_u32 v3, s82, v3
    v_mfma_f32_16x16x32_bf16 v[88:91], v[136:139], v[156:159], v[88:91]
    v_add_u32 v4, s82, v4
    v_add_u32 v5, s82, v5
    v_mfma_f32_16x16x32_bf16 v[92:95], v[160:163], v[124:127], v[92:95]
    v_add_u32 v6, s82, v6
    v_add_u32 v7, s82, v7
    v_mfma_f32_16x16x32_bf16 v[96:99], v[160:163], v[128:131], v[96:99]
    v_add_u32 v8, s82, v8
    v_add_u32 v9, s82, v9
    v_mfma_f32_16x16x32_bf16 v[100:103], v[160:163], v[132:135], v[100:103]
    v_mfma_f32_16x16x32_bf16 v[104:107], v[160:163], v[136:139], v[104:107]
    v_mfma_f32_16x16x32_bf16 v[108:111], v[164:167], v[124:127], v[108:111]
    v_mfma_f32_16x16x32_bf16 v[112:115], v[164:167], v[128:131], v[112:115]
    s_bitcmp0_b32 0x28, s83
    s_cbranch_scc1 Lvw_87
    s_waitcnt vmcnt(0)
Lvw_87:
    s_bitcmp1_b32 s11, s83
    s_cbranch_scc1 Lx0
Lret0_0:
    v_mfma_f32_16x16x32_bf16 v[116:119], v[164:167], v[132:135], v[116:119]
    s_cmp_lt_u32 s83, 5
    v_mfma_f32_16x16x32_bf16 v[120:123], v[164:167], v[136:139], v[120:123]
    s_waitcnt lgkmcnt(0)
    s_cbranch_scc1 Lp1h_0_1
.p2align 3
Lp1h_0_0:
    s_barrier
    v_mfma_f32_16x16x32_bf16 v[12:15], v[168:171], v[184:187], v[12:15]
    v_mfma_f32_16x16x32_bf16 v[16:19], v[172:175], v[184:187], v[16:19]
    v_mfma_f32_16x16x32_bf16 v[20:23], v[176:179], v[184:187], v[20:23]
    ds_read_b128 v[124:127], v2 offset:0
    v_mfma_f32_16x16x32_bf16 v[24:27], v[180:183], v[184:187], v[24:27]
    ds_read_b128 v[128:131], v2 offset:2048
    v_mfma_f32_16x16x32_bf16 v[28:31], v[168:171], v[188:191], v[28:31]
    ds_read_b128 v[132:135], v4 offset:0
    v_mfma_f32_16x16x32_bf16 v[32:35], v[172:175], v[188:191], v[32:35]
    ds_read_b128 v[136:139], v4 offset:2048
    v_mfma_f32_16x16x32_bf16 v[36:39], v[176:179], v[188:191], v[36:39]
    ds_read_b64_tr_b16 v[140:141], v6 offset:0
    v_mfma_f32_16x16x32_bf16 v[40:43], v[180:183], v[188:191], v[40:43]
    ds_read_b64_tr_b16 v[142:143], v6 offset:1280
    v_mfma_f32_16x16x32_bf16 v[44:47], v[168:171], v[192:195], v[44:47]
    ds_read_b64_tr_b16 v[144:145], v6 offset:32
    v_mfma_f32_16x16x32_bf16 v[48:51], v[172:175], v[192:195], v[48:51]
    ds_read_b64_tr_b16 v[146:147], v6 offset:1312
    v_mfma_f32_16x16x32_bf16 v[52:55], v[176:179], v[192:195], v[52:55]
    ds_read_b64_tr_b16 v[148:149], v7 offset:0
    v_mfma_f32_16x16x32_bf16 v[56:59], v[180:183], v[192:195], v[56:59]
    ds_read_b64_tr_b16 v[150:151], v7 offset:1280
    v_mfma_f32_16x16x32_bf16 v[60:63], v[168:171], v[196:199], v[60:63]
    ds_read_b64_tr_b16 v[152:153], v6 offset:10256
    v_mfma_f32_16x16x32_bf16 v[64:67], v[172:175], v[196:199], v[64:67]
    ds_read_b64_tr_b16 v[154:155], v6 offset:11536
    v_mfma_f32_16x16x32_bf16 v[68:71], v[176:179], v[196:199], v[68:71]
    ds_read_b64_tr_b16 v[156:157], v6 offset:10288
    v_mfma_f32_16x16x32_bf16 v[72:75], v[180:183], v[196:199], v[72:75]
    ds_read_b64_tr_b16 v[158:159], v6 offset:11568
    v_mfma_f32_16x16x32_bf16 v[76:79], v[168:171], v[200:203], v[76:79]
    ds_read_b64_tr_b16 v[160:161], v8 offset:0
    v_mfma_f32_16x16x32_bf16 v[80:83], v[172:175], v[200:203], v[80:83]
    ds_read_b64_tr_b16 v[162:163], v8 offset:1024
    v_mfma_f32_16x16x32_bf16 v[84:87], v[176:179], v[200:203], v[84:87]
    ds_read_b64_tr_b16 v[164:165], v9 offset:0
    v_mfma_f32_16x16x32_bf16 v[88:91], v[180:183], v[200:203], v[88:91]
    ds_read_b64_tr_b16 v[166:167], v9 offset:1024
    v_mfma_f32_16x16x32_bf16 v[92:95], v[204:207], v[168:171], v[92:95]
    v_mfma_f32_16x16x32_bf16 v[96:99], v[204:207], v[172:175], v[96:99]
    v_mfma_f32_16x16x32_bf16 v[100:103], v[204:207], v[176:179], v[100:103]
    v_mfma_f32_16x16x32_bf16 v[104:107], v[204:207], v[180:183], v[104:107]
    v_mfma_f32_16x16x32_bf16 v[108:111], v[208:211], v[168:171], v[108:111]
    v_mfma_f32_16x16x32_bf16 v[112:115], v[208:211], v[172:175], v[112:115]
    v_mfma_f32_16x16x32_bf16 v[116:119], v[208:211], v[176:179], v[116:119]
    v_mfma_f32_16x16x32_bf16 v[120:123], v[208:211], v[180:183], v[120:123]
    s_waitcnt lgkmcnt(0)
    v_mfma_f32_16x16x32_bf16 v[12:15], v[124:127], v[140:143], v[12:15]
    s_add_u32 s83, s83, 1
    ds_read_b128 v[168:171], v3 offset:0
    v_mfma_f32_16x16x32_bf16 v[16:19], v[128:131], v[140:143], v[16:19]
    s_bitcmp1_b32 0x248, s83
    ds_read_b128 v[172:175], v3 offset:2048
    v_mfma_f32_16x16x32_bf16 v[20:23], v[132:135], v[140:143], v[20:23]
    s_cselect_b32 s82, s86, s87
    ds_read_b128 v[176:179], v5 offset:0
    v_mfma_f32_16x16x32_bf16 v[24:27], v[136:139], v[140:143], v[24:27]
    ds_read_b128 v[180:183], v5 offset:2048
    v_mfma_f32_16x16x32_bf16 v[28:31], v[124:127], v[144:147], v[28:31]
    ds_read_b64_tr_b16 v[184:185], v6 offset:5120
    v_mfma_f32_16x16x32_bf16 v[32:35], v[128:131], v[144:147], v[32:35]
    ds_read_b64_tr_b16 v[186:187], v6 offset:6400
    v_mfma_f32_16x16x32_bf16 v[36:39], v[132:135], v[144:147], v[36:39]
    ds_read_b64_tr_b16 v[188:189], v6 offset:5152
    v_mfma_f32_16x16x32_bf16 v[40:43], v[136:139], v[144:147], v[40:43]
    ds_read_b64_tr_b16 v[190:191], v6 offset:6432
    v_mfma_f32_16x16x32_bf16 v[44:47], v[124:127], v[148:151], v[44:47]
    ds_read_b64_tr_b16 v[192:193], v7 offset:5120
    v_mfma_f32_16x16x32_bf16 v[48:51], v[128:131], v[148:151], v[48:51]
    ds_read_b64_tr_b16 v[194:195], v7 offset:6400
    v_mfma_f32_16x16x32_bf16 v[52:55], v[132:135], v[148:151], v[52:55]
    ds_read_b64_tr_b16 v[196:197], v6 offset:15376
    v_mfma_f32_16x16x32_bf16 v[56:59], v[136:139], v[148:151], v[56:59]
    ds_read_b64_tr_b16 v[198:199], v6 offset:16656
    v_mfma_f32_16x16x32_bf16 v[60:63], v[124:127], v[152:155], v[60:63]
    ds_read_b64_tr_b16 v[200:201], v6 offset:15408
    v_mfma_f32_16x16x32_bf16 v[64:67], v[128:131], v[152:155], v[64:67]
    ds_read_b64_tr_b16 v[202:203], v6 offset:16688
    v_mfma_f32_16x16x32_bf16 v[68:71], v[132:135], v[152:155], v[68:71]
    ds_read_b64_tr_b16 v[204:205], v8 offset:4096
    v_mfma_f32_16x16x32_bf16 v[72:75], v[136:139], v[152:155], v[72:75]
    ds_read_b64_tr_b16 v[206:207], v8 offset:5120
    v_mfma_f32_16x16x32_bf16 v[76:79], v[124:127], v[156:159], v[76:79]
    ds_read_b64_tr_b16 v[208:209], v9 offset:4096
    v_mfma_f32_16x16x32_bf16 v[80:83], v[128:131], v[156:159], v[80:83]
    ds_read_b64_tr_b16 v[210:211], v9 offset:5120
    v_mfma_f32_16x16x32_bf16 v[84:87], v[132:135], v[156:159], v[84:87]
    v_add_u32 v2, s82, v2
    v_add_u32 v3, s82, v3
    v_mfma_f32_16x16x32_bf16 v[88:91], v[136:139], v[156:159], v[88:91]
    v_add_u32 v4, s82, v4
    v_add_u32 v5, s82, v5
    v_mfma_f32_16x16x32_bf16 v[92:95], v[160:163], v[124:127], v[92:95]
    v_add_u32 v6, s82, v6
    v_add_u32 v7, s82, v7
    v_mfma_f32_16x16x32_bf16 v[96:99], v[160:163], v[128:131], v[96:99]
    v_add_u32 v8, s82, v8
    v_add_u32 v9, s82, v9
    v_mfma_f32_16x16x32_bf16 v[100:103], v[160:163], v[132:135], v[100:103]
    v_mfma_f32_16x16x32_bf16 v[104:107], v[160:163], v[136:139], v[104:107]
    v_mfma_f32_16x16x32_bf16 v[108:111], v[164:167], v[124:127], v[108:111]
    v_mfma_f32_16x16x32_bf16 v[112:115], v[164:167], v[128:131], v[112:115]
    v_mfma_f32_16x16x32_bf16 v[116:119], v[164:167], v[132:135], v[116:119]
    s_cmp_lt_u32 s83, 10
    v_mfma_f32_16x16x32_bf16 v[120:123], v[164:167], v[136:139], v[120:123]
    s_waitcnt lgkmcnt(0)
    s_cbranch_scc1 Lp1h_0_0
    s_barrier
    s_setprio 2
    s_lshl_b32 s70, s68, 8
    s_lshl_b32 s71, s69, 7
    s_add_u32 s70, s70, s71
    s_add_u32 s70, s70, 86016
    v_lshl_add_u32 v2, v249, 4, s70
    v_xor_b32 v3, 128, v2
    s_mul_i32 s70, s69, 448
    s_add_u32 s70, s70, 88064
    v_lshl_add_u32 v4, v248, 2, s70
    v_lshl_add_u32 v5, v249, 4, s70
    v_xor_b32 v6, 128, v251
    s_lshl_b32 s70, s69, 6
    s_add_u32 s70, s70, 163328
    v_lshl_add_u32 v7, v249, 3, s70
    v_mov_b32 v8, 89088
    ds_read_b128 v[124:127], v2 offset:0
    v_mfma_f32_16x16x32_bf16 v[12:15], v[168:171], v[184:187], v[12:15]
    ds_read_b128 v[128:131], v2 offset:512
    ds_read_b128 v[132:135], v2 offset:64
    v_mfma_f32_16x16x32_bf16 v[16:19], v[172:175], v[184:187], v[16:19]
    ds_read_b128 v[136:139], v2 offset:576
    ds_read_b32 v216, v4 offset:0
    v_mfma_f32_16x16x32_bf16 v[20:23], v[176:179], v[184:187], v[20:23]
    ds_read_b32 v218, v4 offset:64
    v_mfma_f32_16x16x32_bf16 v[24:27], v[180:183], v[184:187], v[24:27]
    ds_read_b32 v220, v4 offset:128
    ds_read_b32 v222, v4 offset:192
    v_mfma_f32_16x16x32_bf16 v[28:31], v[168:171], v[188:191], v[28:31]
    ds_read_b32 v224, v4 offset:256
    v_mfma_f32_16x16x32_bf16 v[32:35], v[172:175], v[188:191], v[32:35]
    ds_read_b128 v[140:143], v3 offset:0
    ds_read_b128 v[144:147], v3 offset:512
    v_mfma_f32_16x16x32_bf16 v[36:39], v[176:179], v[188:191], v[36:39]
    ds_read_b128 v[148:151], v3 offset:64
    ds_read_b128 v[152:155], v3 offset:576
    v_mfma_f32_16x16x32_bf16 v[40:43], v[180:183], v[188:191], v[40:43]
    ds_read_b32 v229, v8
    v_mfma_f32_16x16x32_bf16 v[44:47], v[168:171], v[192:195], v[44:47]
    v_mul_u32_u24 v9, 336, v249
    v_add_u32 v9, s75, v9
    v_mfma_f32_16x16x32_bf16 v[48:51], v[172:175], v[192:195], v[48:51]
    v_lshl_add_u32 v10, v248, 4, v9
    v_mfma_f32_16x16x32_bf16 v[52:55], v[176:179], v[192:195], v[52:55]
    v_add_u32 v217, 4294967168, v10
    v_add_u32 v219, 896, v10
    v_mfma_f32_16x16x32_bf16 v[56:59], v[180:183], v[192:195], v[56:59]
    v_add_u32 v221, 1216, v10
    v_cmp_eq_u32 vcc, 0, v249
    v_mfma_f32_16x16x32_bf16 v[60:63], v[168:171], v[196:199], v[60:63]
    s_nop 0
    v_cndmask_b32 v219, v219, v221, vcc
    v_mfma_f32_16x16x32_bf16 v[64:67], v[172:175], v[196:199], v[64:67]
    v_add_u32 v221, 2240, v10
    v_cmp_eq_u32 vcc, 0, v248
    v_mfma_f32_16x16x32_bf16 v[68:71], v[176:179], v[196:199], v[68:71]
    v_add_u32 v10, 320, v9
    v_mfma_f32_16x16x32_bf16 v[72:75], v[180:183], v[196:199], v[72:75]
    v_cndmask_b32 v223, v217, v10, vcc
    v_add_u32 v10, 1664, v9
    v_mfma_f32_16x16x32_bf16 v[76:79], v[168:171], v[200:203], v[76:79]
    v_cndmask_b32 v225, v219, v10, vcc
    v_add_u32 v10, 3008, v9
    v_mfma_f32_16x16x32_bf16 v[80:83], v[172:175], v[200:203], v[80:83]
    v_cndmask_b32 v227, v221, v10, vcc
    v_mfma_f32_16x16x32_bf16 v[84:87], v[176:179], v[200:203], v[84:87]
    v_mov_b32 v160, 0x358637bd
    v_mov_b32 v162, 0xb58637bd
    v_mfma_f32_16x16x32_bf16 v[88:91], v[180:183], v[200:203], v[88:91]
    s_mov_b32 s100, 0x3fb8aa3b
    s_waitcnt lgkmcnt(0)
    v_cmp_gt_u32 s[84:85], 8, v248
    v_pk_fma_f32 v[230:231], v[128:129], v[216:217], v[160:161] op_sel:[0,0,0] op_sel_hi:[1,0,0]
    v_pk_fma_f32 v[232:233], v[130:131], v[216:217], v[160:161] op_sel:[0,0,0] op_sel_hi:[1,0,0]
    v_pk_fma_f32 v[234:235], v[136:137], v[216:217], v[160:161] op_sel:[0,0,0] op_sel_hi:[1,0,0]
    v_pk_fma_f32 v[236:237], v[138:139], v[216:217], v[160:161] op_sel:[0,0,0] op_sel_hi:[1,0,0]
    v_pk_fma_f32 v[12:13], v[124:125], v[12:13], v[230:231] op_sel:[0,0,0] op_sel_hi:[1,1,1]
    v_pk_fma_f32 v[14:15], v[126:127], v[14:15], v[232:233] op_sel:[0,0,0] op_sel_hi:[1,1,1]
    v_pk_fma_f32 v[16:17], v[132:133], v[16:17], v[234:235] op_sel:[0,0,0] op_sel_hi:[1,1,1]
    v_pk_fma_f32 v[18:19], v[134:135], v[18:19], v[236:237] op_sel:[0,0,0] op_sel_hi:[1,1,1]
    v_pk_mul_f32 v[230:231], v[12:13], s[100:101] op_sel:[0,0] op_sel_hi:[1,0]
    v_pk_mul_f32 v[232:233], v[14:15], s[100:101] op_sel:[0,0] op_sel_hi:[1,0]
    v_pk_mul_f32 v[234:235], v[16:17], s[100:101] op_sel:[0,0] op_sel_hi:[1,0]
    v_pk_mul_f32 v[236:237], v[18:19], s[100:101] op_sel:[0,0] op_sel_hi:[1,0]
    v_exp_f32 v230, v230 clamp
    v_exp_f32 v231, v231 clamp
    v_exp_f32 v232, v232 clamp
    v_exp_f32 v233, v233 clamp
    v_exp_f32 v234, v234 clamp
    v_exp_f32 v235, v235 clamp
    v_exp_f32 v236, v236 clamp
    v_exp_f32 v237, v237 clamp
    v_max_f32 v238, v160, v12
    v_max_f32 v239, v160, v13
    v_max_f32 v240, v160, v14
    v_max_f32 v241, v160, v15
    v_max_f32 v242, v160, v16
    v_max_f32 v243, v160, v17
    v_max_f32 v244, v160, v18
    v_max_f32 v245, v160, v19
    v_pk_add_f32 v[230:231], v[230:231], v[238:239] op_sel:[0,0] op_sel_hi:[1,1]
    v_pk_add_f32 v[232:233], v[232:233], v[240:241] op_sel:[0,0] op_sel_hi:[1,1]
    v_pk_add_f32 v[234:235], v[234:235], v[242:243] op_sel:[0,0] op_sel_hi:[1,1]
    v_pk_add_f32 v[236:237], v[236:237], v[244:245] op_sel:[0,0] op_sel_hi:[1,1]
    v_cvt_pk_bf16_f32 v184, v230, v231
    v_cvt_pk_bf16_f32 v185, v232, v233
    v_cvt_pk_bf16_f32 v186, v234, v235
    v_cvt_pk_bf16_f32 v187, v236, v237
    v_pk_fma_f32 v[230:231], v[128:129], v[218:219], v[160:161] op_sel:[0,0,0] op_sel_hi:[1,0,0]
    v_pk_fma_f32 v[232:233], v[130:131], v[218:219], v[160:161] op_sel:[0,0,0] op_sel_hi:[1,0,0]
    v_pk_fma_f32 v[234:235], v[136:137], v[218:219], v[160:161] op_sel:[0,0,0] op_sel_hi:[1,0,0]
    v_pk_fma_f32 v[236:237], v[138:139], v[218:219], v[160:161] op_sel:[0,0,0] op_sel_hi:[1,0,0]
    v_pk_fma_f32 v[28:29], v[124:125], v[28:29], v[230:231] op_sel:[0,0,0] op_sel_hi:[1,1,1]
    v_pk_fma_f32 v[30:31], v[126:127], v[30:31], v[232:233] op_sel:[0,0,0] op_sel_hi:[1,1,1]
    v_pk_fma_f32 v[32:33], v[132:133], v[32:33], v[234:235] op_sel:[0,0,0] op_sel_hi:[1,1,1]
    v_pk_fma_f32 v[34:35], v[134:135], v[34:35], v[236:237] op_sel:[0,0,0] op_sel_hi:[1,1,1]
    v_pk_mul_f32 v[230:231], v[28:29], s[100:101] op_sel:[0,0] op_sel_hi:[1,0]
    v_pk_mul_f32 v[232:233], v[30:31], s[100:101] op_sel:[0,0] op_sel_hi:[1,0]
    v_pk_mul_f32 v[234:235], v[32:33], s[100:101] op_sel:[0,0] op_sel_hi:[1,0]
    v_pk_mul_f32 v[236:237], v[34:35], s[100:101] op_sel:[0,0] op_sel_hi:[1,0]
    v_exp_f32 v230, v230 clamp
    v_exp_f32 v231, v231 clamp
    v_exp_f32 v232, v232 clamp
    v_exp_f32 v233, v233 clamp
    v_exp_f32 v234, v234 clamp
    v_exp_f32 v235, v235 clamp
    v_exp_f32 v236, v236 clamp
    v_exp_f32 v237, v237 clamp
    v_max_f32 v238, v160, v28
    v_max_f32 v239, v160, v29
    v_max_f32 v240, v160, v30
    v_max_f32 v241, v160, v31
    v_max_f32 v242, v160, v32
    v_max_f32 v243, v160, v33
    v_max_f32 v244, v160, v34
    v_max_f32 v245, v160, v35
    v_pk_add_f32 v[230:231], v[230:231], v[238:239] op_sel:[0,0] op_sel_hi:[1,1]
    v_pk_add_f32 v[232:233], v[232:233], v[240:241] op_sel:[0,0] op_sel_hi:[1,1]
    v_pk_add_f32 v[234:235], v[234:235], v[242:243] op_sel:[0,0] op_sel_hi:[1,1]
    v_pk_add_f32 v[236:237], v[236:237], v[244:245] op_sel:[0,0] op_sel_hi:[1,1]
    v_cvt_pk_bf16_f32 v188, v230, v231
    v_cvt_pk_bf16_f32 v189, v232, v233
    v_cvt_pk_bf16_f32 v190, v234, v235
    v_cvt_pk_bf16_f32 v191, v236, v237
    v_pk_fma_f32 v[230:231], v[128:129], v[220:221], v[160:161] op_sel:[0,0,0] op_sel_hi:[1,0,0]
    v_pk_fma_f32 v[232:233], v[130:131], v[220:221], v[160:161] op_sel:[0,0,0] op_sel_hi:[1,0,0]
    v_pk_fma_f32 v[234:235], v[136:137], v[220:221], v[160:161] op_sel:[0,0,0] op_sel_hi:[1,0,0]
    v_pk_fma_f32 v[236:237], v[138:139], v[220:221], v[160:161] op_sel:[0,0,0] op_sel_hi:[1,0,0]
    v_pk_fma_f32 v[44:45], v[124:125], v[44:45], v[230:231] op_sel:[0,0,0] op_sel_hi:[1,1,1]
    v_pk_fma_f32 v[46:47], v[126:127], v[46:47], v[232:233] op_sel:[0,0,0] op_sel_hi:[1,1,1]
    v_pk_fma_f32 v[48:49], v[132:133], v[48:49], v[234:235] op_sel:[0,0,0] op_sel_hi:[1,1,1]
    v_pk_fma_f32 v[50:51], v[134:135], v[50:51], v[236:237] op_sel:[0,0,0] op_sel_hi:[1,1,1]
    v_pk_mul_f32 v[230:231], v[44:45], s[100:101] op_sel:[0,0] op_sel_hi:[1,0]
    v_pk_mul_f32 v[232:233], v[46:47], s[100:101] op_sel:[0,0] op_sel_hi:[1,0]
    v_pk_mul_f32 v[234:235], v[48:49], s[100:101] op_sel:[0,0] op_sel_hi:[1,0]
    v_pk_mul_f32 v[236:237], v[50:51], s[100:101] op_sel:[0,0] op_sel_hi:[1,0]
    v_exp_f32 v230, v230 clamp
    v_exp_f32 v231, v231 clamp
    v_exp_f32 v232, v232 clamp
    v_exp_f32 v233, v233 clamp
    v_exp_f32 v234, v234 clamp
    v_exp_f32 v235, v235 clamp
    v_exp_f32 v236, v236 clamp
    v_exp_f32 v237, v237 clamp
    v_max_f32 v238, v160, v44
    v_max_f32 v239, v160, v45
    v_max_f32 v240, v160, v46
    v_max_f32 v241, v160, v47
    v_max_f32 v242, v160, v48
    v_max_f32 v243, v160, v49
    v_max_f32 v244, v160, v50
    v_max_f32 v245, v160, v51
    v_pk_add_f32 v[230:231], v[230:231], v[238:239] op_sel:[0,0] op_sel_hi:[1,1]
    v_pk_add_f32 v[232:233], v[232:233], v[240:241] op_sel:[0,0] op_sel_hi:[1,1]
    v_pk_add_f32 v[234:235], v[234:235], v[242:243] op_sel:[0,0] op_sel_hi:[1,1]
    v_pk_add_f32 v[236:237], v[236:237], v[244:245] op_sel:[0,0] op_sel_hi:[1,1]
    v_cvt_pk_bf16_f32 v192, v230, v231
    v_cvt_pk_bf16_f32 v193, v232, v233
    v_cvt_pk_bf16_f32 v194, v234, v235
    v_cvt_pk_bf16_f32 v195, v236, v237
    v_pk_add_f32 v[230:231], v[44:45], v[162:163] op_sel:[0,0] op_sel_hi:[1,0]
    v_pk_add_f32 v[232:233], v[46:47], v[162:163] op_sel:[0,0] op_sel_hi:[1,0]
    v_pk_add_f32 v[234:235], v[48:49], v[162:163] op_sel:[0,0] op_sel_hi:[1,0]
    v_pk_add_f32 v[236:237], v[50:51], v[162:163] op_sel:[0,0] op_sel_hi:[1,0]
    v_cvt_pk_bf16_f32 v196, v230, v231
    v_cvt_pk_bf16_f32 v197, v232, v233
    v_cvt_pk_bf16_f32 v198, v234, v235
    v_cvt_pk_bf16_f32 v199, v236, v237
    v_pk_mul_f32 v[230:231], v[128:129], v[222:223] op_sel:[0,0] op_sel_hi:[1,0]
    v_pk_mul_f32 v[232:233], v[130:131], v[222:223] op_sel:[0,0] op_sel_hi:[1,0]
    v_pk_mul_f32 v[234:235], v[136:137], v[222:223] op_sel:[0,0] op_sel_hi:[1,0]
    v_pk_mul_f32 v[236:237], v[138:139], v[222:223] op_sel:[0,0] op_sel_hi:[1,0]
    v_pk_fma_f32 v[230:231], v[124:125], v[60:61], v[230:231] op_sel:[0,0,0] op_sel_hi:[1,1,1]
    v_pk_fma_f32 v[232:233], v[126:127], v[62:63], v[232:233] op_sel:[0,0,0] op_sel_hi:[1,1,1]
    v_pk_fma_f32 v[234:235], v[132:133], v[64:65], v[234:235] op_sel:[0,0,0] op_sel_hi:[1,1,1]
    v_pk_fma_f32 v[236:237], v[134:135], v[66:67], v[236:237] op_sel:[0,0,0] op_sel_hi:[1,1,1]
    v_cvt_pk_bf16_f32 v200, v230, v231
    v_cvt_pk_bf16_f32 v201, v232, v233
    v_cvt_pk_bf16_f32 v202, v234, v235
    v_cvt_pk_bf16_f32 v203, v236, v237
    v_pk_mul_f32 v[230:231], v[128:129], v[224:225] op_sel:[0,0] op_sel_hi:[1,0]
    v_pk_mul_f32 v[232:233], v[130:131], v[224:225] op_sel:[0,0] op_sel_hi:[1,0]
    v_pk_mul_f32 v[234:235], v[136:137], v[224:225] op_sel:[0,0] op_sel_hi:[1,0]
    v_pk_mul_f32 v[236:237], v[138:139], v[224:225] op_sel:[0,0] op_sel_hi:[1,0]
    v_pk_fma_f32 v[230:231], v[124:125], v[76:77], v[230:231] op_sel:[0,0,0] op_sel_hi:[1,1,1]
    v_pk_fma_f32 v[232:233], v[126:127], v[78:79], v[232:233] op_sel:[0,0,0] op_sel_hi:[1,1,1]
    v_pk_fma_f32 v[234:235], v[132:133], v[80:81], v[234:235] op_sel:[0,0,0] op_sel_hi:[1,1,1]
    v_pk_fma_f32 v[236:237], v[134:135], v[82:83], v[236:237] op_sel:[0,0,0] op_sel_hi:[1,1,1]
    v_cvt_pk_bf16_f32 v156, v230, v231
    v_cvt_pk_bf16_f32 v157, v232, v233
    v_cvt_pk_bf16_f32 v158, v234, v235
    v_cvt_pk_bf16_f32 v159, v236, v237
    v_cndmask_b32 v196, v196, v212, s[84:85]
    v_cndmask_b32 v197, v197, v212, s[84:85]
    v_cndmask_b32 v198, v198, v212, s[84:85]
    v_cndmask_b32 v199, v199, v212, s[84:85]
    s_nop 1
    v_mfma_f32_16x16x32_bf16 v[12:15], v[184:187], v[196:199], 0
    v_mfma_f32_16x16x32_bf16 v[16:19], v[184:187], v[200:203], 0
    v_mfma_f32_16x16x32_bf16 v[28:31], v[188:191], v[196:199], 0
    v_mfma_f32_16x16x32_bf16 v[32:35], v[188:191], v[200:203], 0
    v_mfma_f32_16x16x32_bf16 v[44:47], v[188:191], v[156:159], 0
    v_mfma_f32_16x16x32_bf16 v[48:51], v[192:195], v[196:199], 0
    v_mfma_f32_16x16x32_bf16 v[60:63], v[192:195], v[200:203], 0
    v_mfma_f32_16x16x32_bf16 v[64:67], v[192:195], v[156:159], 0
    v_pk_fma_f32 v[230:231], v[144:145], v[216:217], v[160:161] op_sel:[0,0,0] op_sel_hi:[1,0,0]
    v_pk_fma_f32 v[232:233], v[146:147], v[216:217], v[160:161] op_sel:[0,0,0] op_sel_hi:[1,0,0]
    v_pk_fma_f32 v[234:235], v[152:153], v[216:217], v[160:161] op_sel:[0,0,0] op_sel_hi:[1,0,0]
    v_pk_fma_f32 v[236:237], v[154:155], v[216:217], v[160:161] op_sel:[0,0,0] op_sel_hi:[1,0,0]
    v_pk_fma_f32 v[20:21], v[140:141], v[20:21], v[230:231] op_sel:[0,0,0] op_sel_hi:[1,1,1]
    v_pk_fma_f32 v[22:23], v[142:143], v[22:23], v[232:233] op_sel:[0,0,0] op_sel_hi:[1,1,1]
    v_pk_fma_f32 v[24:25], v[148:149], v[24:25], v[234:235] op_sel:[0,0,0] op_sel_hi:[1,1,1]
    v_pk_fma_f32 v[26:27], v[150:151], v[26:27], v[236:237] op_sel:[0,0,0] op_sel_hi:[1,1,1]
    v_pk_mul_f32 v[230:231], v[20:21], s[100:101] op_sel:[0,0] op_sel_hi:[1,0]
    v_pk_mul_f32 v[232:233], v[22:23], s[100:101] op_sel:[0,0] op_sel_hi:[1,0]
    v_pk_mul_f32 v[234:235], v[24:25], s[100:101] op_sel:[0,0] op_sel_hi:[1,0]
    v_pk_mul_f32 v[236:237], v[26:27], s[100:101] op_sel:[0,0] op_sel_hi:[1,0]
    v_exp_f32 v230, v230 clamp
    v_exp_f32 v231, v231 clamp
    v_exp_f32 v232, v232 clamp
    v_exp_f32 v233, v233 clamp
    v_exp_f32 v234, v234 clamp
    v_exp_f32 v235, v235 clamp
    v_exp_f32 v236, v236 clamp
    v_exp_f32 v237, v237 clamp
    v_max_f32 v238, v160, v20
    v_max_f32 v239, v160, v21
    v_max_f32 v240, v160, v22
    v_max_f32 v241, v160, v23
    v_max_f32 v242, v160, v24
    v_max_f32 v243, v160, v25
    v_max_f32 v244, v160, v26
    v_max_f32 v245, v160, v27
    v_pk_add_f32 v[230:231], v[230:231], v[238:239] op_sel:[0,0] op_sel_hi:[1,1]
    v_pk_add_f32 v[232:233], v[232:233], v[240:241] op_sel:[0,0] op_sel_hi:[1,1]
    v_pk_add_f32 v[234:235], v[234:235], v[242:243] op_sel:[0,0] op_sel_hi:[1,1]
    v_pk_add_f32 v[236:237], v[236:237], v[244:245] op_sel:[0,0] op_sel_hi:[1,1]
    v_cvt_pk_bf16_f32 v184, v230, v231
    v_cvt_pk_bf16_f32 v185, v232, v233
    v_cvt_pk_bf16_f32 v186, v234, v235
    v_cvt_pk_bf16_f32 v187, v236, v237
    v_pk_fma_f32 v[230:231], v[144:145], v[218:219], v[160:161] op_sel:[0,0,0] op_sel_hi:[1,0,0]
    v_pk_fma_f32 v[232:233], v[146:147], v[218:219], v[160:161] op_sel:[0,0,0] op_sel_hi:[1,0,0]
    v_pk_fma_f32 v[234:235], v[152:153], v[218:219], v[160:161] op_sel:[0,0,0] op_sel_hi:[1,0,0]
    v_pk_fma_f32 v[236:237], v[154:155], v[218:219], v[160:161] op_sel:[0,0,0] op_sel_hi:[1,0,0]
    v_pk_fma_f32 v[36:37], v[140:141], v[36:37], v[230:231] op_sel:[0,0,0] op_sel_hi:[1,1,1]
    v_pk_fma_f32 v[38:39], v[142:143], v[38:39], v[232:233] op_sel:[0,0,0] op_sel_hi:[1,1,1]
    v_pk_fma_f32 v[40:41], v[148:149], v[40:41], v[234:235] op_sel:[0,0,0] op_sel_hi:[1,1,1]
    v_pk_fma_f32 v[42:43], v[150:151], v[42:43], v[236:237] op_sel:[0,0,0] op_sel_hi:[1,1,1]
    v_pk_mul_f32 v[230:231], v[36:37], s[100:101] op_sel:[0,0] op_sel_hi:[1,0]
    v_pk_mul_f32 v[232:233], v[38:39], s[100:101] op_sel:[0,0] op_sel_hi:[1,0]
    v_pk_mul_f32 v[234:235], v[40:41], s[100:101] op_sel:[0,0] op_sel_hi:[1,0]
    v_pk_mul_f32 v[236:237], v[42:43], s[100:101] op_sel:[0,0] op_sel_hi:[1,0]
    v_exp_f32 v230, v230 clamp
    v_exp_f32 v231, v231 clamp
    v_exp_f32 v232, v232 clamp
    v_exp_f32 v233, v233 clamp
    v_exp_f32 v234, v234 clamp
    v_exp_f32 v235, v235 clamp
    v_exp_f32 v236, v236 clamp
    v_exp_f32 v237, v237 clamp
    v_max_f32 v238, v160, v36
    v_max_f32 v239, v160, v37
    v_max_f32 v240, v160, v38
    v_max_f32 v241, v160, v39
    v_max_f32 v242, v160, v40
    v_max_f32 v243, v160, v41
    v_max_f32 v244, v160, v42
    v_max_f32 v245, v160, v43
    v_pk_add_f32 v[230:231], v[230:231], v[238:239] op_sel:[0,0] op_sel_hi:[1,1]
    v_pk_add_f32 v[232:233], v[232:233], v[240:241] op_sel:[0,0] op_sel_hi:[1,1]
    v_pk_add_f32 v[234:235], v[234:235], v[242:243] op_sel:[0,0] op_sel_hi:[1,1]
    v_pk_add_f32 v[236:237], v[236:237], v[244:245] op_sel:[0,0] op_sel_hi:[1,1]
    v_cvt_pk_bf16_f32 v188, v230, v231
    v_cvt_pk_bf16_f32 v189, v232, v233
    v_cvt_pk_bf16_f32 v190, v234, v235
    v_cvt_pk_bf16_f32 v191, v236, v237
    v_pk_fma_f32 v[230:231], v[144:145], v[220:221], v[160:161] op_sel:[0,0,0] op_sel_hi:[1,0,0]
    v_pk_fma_f32 v[232:233], v[146:147], v[220:221], v[160:161] op_sel:[0,0,0] op_sel_hi:[1,0,0]
    v_pk_fma_f32 v[234:235], v[152:153], v[220:221], v[160:161] op_sel:[0,0,0] op_sel_hi:[1,0,0]
    v_pk_fma_f32 v[236:237], v[154:155], v[220:221], v[160:161] op_sel:[0,0,0] op_sel_hi:[1,0,0]
    v_pk_fma_f32 v[52:53], v[140:141], v[52:53], v[230:231] op_sel:[0,0,0] op_sel_hi:[1,1,1]
    v_pk_fma_f32 v[54:55], v[142:143], v[54:55], v[232:233] op_sel:[0,0,0] op_sel_hi:[1,1,1]
    v_pk_fma_f32 v[56:57], v[148:149], v[56:57], v[234:235] op_sel:[0,0,0] op_sel_hi:[1,1,1]
    v_pk_fma_f32 v[58:59], v[150:151], v[58:59], v[236:237] op_sel:[0,0,0] op_sel_hi:[1,1,1]
    v_pk_mul_f32 v[230:231], v[52:53], s[100:101] op_sel:[0,0] op_sel_hi:[1,0]
    v_pk_mul_f32 v[232:233], v[54:55], s[100:101] op_sel:[0,0] op_sel_hi:[1,0]
    v_pk_mul_f32 v[234:235], v[56:57], s[100:101] op_sel:[0,0] op_sel_hi:[1,0]
    v_pk_mul_f32 v[236:237], v[58:59], s[100:101] op_sel:[0,0] op_sel_hi:[1,0]
    v_exp_f32 v230, v230 clamp
    v_exp_f32 v231, v231 clamp
    v_exp_f32 v232, v232 clamp
    v_exp_f32 v233, v233 clamp
    v_exp_f32 v234, v234 clamp
    v_exp_f32 v235, v235 clamp
    v_exp_f32 v236, v236 clamp
    v_exp_f32 v237, v237 clamp
    v_max_f32 v238, v160, v52
    v_max_f32 v239, v160, v53
    v_max_f32 v240, v160, v54
    v_max_f32 v241, v160, v55
    v_max_f32 v242, v160, v56
    v_max_f32 v243, v160, v57
    v_max_f32 v244, v160, v58
    v_max_f32 v245, v160, v59
    v_pk_add_f32 v[230:231], v[230:231], v[238:239] op_sel:[0,0] op_sel_hi:[1,1]
    v_pk_add_f32 v[232:233], v[232:233], v[240:241] op_sel:[0,0] op_sel_hi:[1,1]
    v_pk_add_f32 v[234:235], v[234:235], v[242:243] op_sel:[0,0] op_sel_hi:[1,1]
    v_pk_add_f32 v[236:237], v[236:237], v[244:245] op_sel:[0,0] op_sel_hi:[1,1]
    v_cvt_pk_bf16_f32 v192, v230, v231
    v_cvt_pk_bf16_f32 v193, v232, v233
    v_cvt_pk_bf16_f32 v194, v234, v235
    v_cvt_pk_bf16_f32 v195, v236, v237
    v_pk_add_f32 v[230:231], v[52:53], v[162:163] op_sel:[0,0] op_sel_hi:[1,0]
    v_pk_add_f32 v[232:233], v[54:55], v[162:163] op_sel:[0,0] op_sel_hi:[1,0]
    v_pk_add_f32 v[234:235], v[56:57], v[162:163] op_sel:[0,0] op_sel_hi:[1,0]
    v_pk_add_f32 v[236:237], v[58:59], v[162:163] op_sel:[0,0] op_sel_hi:[1,0]
    v_cvt_pk_bf16_f32 v196, v230, v231
    v_cvt_pk_bf16_f32 v197, v232, v233
    v_cvt_pk_bf16_f32 v198, v234, v235
    v_cvt_pk_bf16_f32 v199, v236, v237
    v_pk_mul_f32 v[230:231], v[144:145], v[222:223] op_sel:[0,0] op_sel_hi:[1,0]
    v_pk_mul_f32 v[232:233], v[146:147], v[222:223] op_sel:[0,0] op_sel_hi:[1,0]
    v_pk_mul_f32 v[234:235], v[152:153], v[222:223] op_sel:[0,0] op_sel_hi:[1,0]
    v_pk_mul_f32 v[236:237], v[154:155], v[222:223] op_sel:[0,0] op_sel_hi:[1,0]
    v_pk_fma_f32 v[230:231], v[140:141], v[68:69], v[230:231] op_sel:[0,0,0] op_sel_hi:[1,1,1]
    v_pk_fma_f32 v[232:233], v[142:143], v[70:71], v[232:233] op_sel:[0,0,0] op_sel_hi:[1,1,1]
    v_pk_fma_f32 v[234:235], v[148:149], v[72:73], v[234:235] op_sel:[0,0,0] op_sel_hi:[1,1,1]
    v_pk_fma_f32 v[236:237], v[150:151], v[74:75], v[236:237] op_sel:[0,0,0] op_sel_hi:[1,1,1]
    v_cvt_pk_bf16_f32 v200, v230, v231
    v_cvt_pk_bf16_f32 v201, v232, v233
    v_cvt_pk_bf16_f32 v202, v234, v235
    v_cvt_pk_bf16_f32 v203, v236, v237
    v_pk_mul_f32 v[230:231], v[144:145], v[224:225] op_sel:[0,0] op_sel_hi:[1,0]
    v_pk_mul_f32 v[232:233], v[146:147], v[224:225] op_sel:[0,0] op_sel_hi:[1,0]
    v_pk_mul_f32 v[234:235], v[152:153], v[224:225] op_sel:[0,0] op_sel_hi:[1,0]
    v_pk_mul_f32 v[236:237], v[154:155], v[224:225] op_sel:[0,0] op_sel_hi:[1,0]
    v_pk_fma_f32 v[230:231], v[140:141], v[84:85], v[230:231] op_sel:[0,0,0] op_sel_hi:[1,1,1]
    v_pk_fma_f32 v[232:233], v[142:143], v[86:87], v[232:233] op_sel:[0,0,0] op_sel_hi:[1,1,1]
    v_pk_fma_f32 v[234:235], v[148:149], v[88:89], v[234:235] op_sel:[0,0,0] op_sel_hi:[1,1,1]
    v_pk_fma_f32 v[236:237], v[150:151], v[90:91], v[236:237] op_sel:[0,0,0] op_sel_hi:[1,1,1]
    v_cvt_pk_bf16_f32 v156, v230, v231
    v_cvt_pk_bf16_f32 v157, v232, v233
    v_cvt_pk_bf16_f32 v158, v234, v235
    v_cvt_pk_bf16_f32 v159, v236, v237
    v_cndmask_b32 v196, v196, v212, s[84:85]
    v_cndmask_b32 v197, v197, v212, s[84:85]
    v_cndmask_b32 v198, v198, v212, s[84:85]
    v_cndmask_b32 v199, v199, v212, s[84:85]
    s_nop 1
    v_mfma_f32_16x16x32_bf16 v[12:15], v[184:187], v[196:199], v[12:15]
    v_mfma_f32_16x16x32_bf16 v[16:19], v[184:187], v[200:203], v[16:19]
    v_mfma_f32_16x16x32_bf16 v[28:31], v[188:191], v[196:199], v[28:31]
    v_mfma_f32_16x16x32_bf16 v[32:35], v[188:191], v[200:203], v[32:35]
    v_mfma_f32_16x16x32_bf16 v[44:47], v[188:191], v[156:159], v[44:47]
    v_mfma_f32_16x16x32_bf16 v[48:51], v[192:195], v[196:199], v[48:51]
    v_mfma_f32_16x16x32_bf16 v[60:63], v[192:195], v[200:203], v[60:63]
    v_mfma_f32_16x16x32_bf16 v[64:67], v[192:195], v[156:159], v[64:67]
    v_lshlrev_b32 v3, 4, v0
    v_add_u32 v4, 135168, v3
    v_mov_b32 v8, 0x40000000
    v_add_u32 v9, 4096, v3
    v_cmp_gt_u32 vcc, 164, v0
    s_nop 1
    v_cndmask_b32 v9, v8, v9, vcc
    v_lshlrev_b32 v2, 4, v1
    s_mov_b32 exec_lo, 0xff01ff01
    s_mov_b32 exec_hi, 0xff01ff01
    ds_write_b128 v223, v[12:15] offset:0
    s_mov_b32 exec_lo, 0xfff0fff
    s_mov_b32 exec_hi, 0xfff0fff
    ds_write_b128 v217, v[16:19] offset:256
    s_mov_b32 exec_lo, 0x1ff01
    s_mov_b32 exec_hi, 0x10001
    ds_write_b128 v225, v[28:31] offset:0
    s_mov_b32 exec_lo, 0xf0000fff
    s_mov_b32 exec_hi, 0xf000f000
    ds_write_b128 v219, v[32:35] offset:256
    s_mov_b32 exec_lo, 0xffff0000
    s_mov_b32 exec_hi, 0xffffffff
    ds_write_b128 v219, v[44:47] offset:512
    s_mov_b32 exec_lo, 0x10001
    s_mov_b32 exec_hi, 0x0
    ds_write_b128 v227, v[48:51] offset:0
    s_mov_b32 exec_lo, 0xf000f000
    s_mov_b32 exec_hi, 0x0
    ds_write_b128 v221, v[60:63] offset:256
    s_mov_b32 exec_lo, 0xffffffff
    s_mov_b32 exec_hi, 0x0
    ds_write_b128 v221, v[64:67] offset:512
    s_mov_b64 exec, -1
    s_mov_b32 s70, 0x7060500
    s_mov_b32 s71, 0x7060501
    s_mov_b32 s72, 0x7060502
    s_mov_b32 s73, 0x7060503
    s_waitcnt lgkmcnt(0)
    s_barrier
    ds_read_b128 v[12:15], v4 offset:0
    ds_read_b128 v[16:19], v4 offset:6720
    ds_read_b128 v[20:23], v4 offset:4096
    ds_read_b128 v[24:27], v4 offset:10816
    s_waitcnt lgkmcnt(2)
    v_pk_add_f32 v[12:13], v[12:13], v[16:17] op_sel:[0,0] op_sel_hi:[1,1]
    v_pk_add_f32 v[14:15], v[14:15], v[18:19] op_sel:[0,0] op_sel_hi:[1,1]
    v_perm_b32 v12, v12, v229, s70
    v_perm_b32 v13, v13, v229, s71
    v_perm_b32 v14, v14, v229, s72
    v_perm_b32 v15, v15, v229, s73
    buffer_store_dwordx4 v[12:15], v3, s[44:47], s80 offen sc1
    s_waitcnt lgkmcnt(0)
    v_pk_add_f32 v[20:21], v[20:21], v[24:25] op_sel:[0,0] op_sel_hi:[1,1]
    v_pk_add_f32 v[22:23], v[22:23], v[26:27] op_sel:[0,0] op_sel_hi:[1,1]
    v_perm_b32 v20, v20, v229, s70
    v_perm_b32 v21, v21, v229, s71
    v_perm_b32 v22, v22, v229, s72
    v_perm_b32 v23, v23, v229, s73
    buffer_store_dwordx4 v[20:23], v9, s[44:47], s80 offen sc1
    s_mov_b32 s100, 0xbdd2d3e8
    s_mov_b32 s101, 0xffff0000
    v_mov_b32 v250, 0xc0135761
    ds_read_b32 v230, v251 offset:1024
    ds_read_b32 v232, v251 offset:1536
    ds_read_b32 v234, v251 offset:1088
    ds_read_b32 v236, v251 offset:1600
    v_mfma_f32_16x16x32_bf16 v[92:95], v[204:207], v[168:171], v[92:95]
    ds_read_b32 v238, v6 offset:1024
    v_mfma_f32_16x16x32_bf16 v[96:99], v[204:207], v[172:175], v[96:99]
    ds_read_b32 v240, v6 offset:1536
    v_mfma_f32_16x16x32_bf16 v[100:103], v[204:207], v[176:179], v[100:103]
    ds_read_b32 v242, v6 offset:1088
    v_mfma_f32_16x16x32_bf16 v[104:107], v[204:207], v[180:183], v[104:107]
    ds_read_b32 v244, v6 offset:1600
    v_mfma_f32_16x16x32_bf16 v[108:111], v[208:211], v[168:171], v[108:111]
    ds_read_b128 v[124:127], v5 offset:320
    v_mfma_f32_16x16x32_bf16 v[112:115], v[208:211], v[172:175], v[112:115]
    ds_read_b64 v[132:133], v7 offset:0
    v_mfma_f32_16x16x32_bf16 v[116:119], v[208:211], v[176:179], v[116:119]
    ds_read_b128 v[128:131], v5 offset:384
    v_mfma_f32_16x16x32_bf16 v[120:123], v[208:211], v[180:183], v[120:123]
    ds_read_b64 v[134:135], v7 offset:32
    s_waitcnt lgkmcnt(0)
    v_lshlrev_b32 v184, 16, v132
    v_and_b32 v185, s101, v132
    v_lshlrev_b32 v186, 16, v133
    v_and_b32 v187, s101, v133
    v_pk_fma_f32 v[192:193], v[232:233], v[124:125], v[184:185] op_sel:[0,0,0] op_sel_hi:[0,1,1]
    v_pk_fma_f32 v[194:195], v[232:233], v[126:127], v[186:187] op_sel:[0,0,0] op_sel_hi:[0,1,1]
    v_pk_fma_f32 v[196:197], v[236:237], v[124:125], v[184:185] op_sel:[0,0,0] op_sel_hi:[0,1,1]
    v_pk_fma_f32 v[198:199], v[236:237], v[126:127], v[186:187] op_sel:[0,0,0] op_sel_hi:[0,1,1]
    v_pk_fma_f32 v[92:93], v[230:231], v[92:93], v[192:193] op_sel:[0,0,0] op_sel_hi:[0,1,1]
    v_pk_fma_f32 v[94:95], v[230:231], v[94:95], v[194:195] op_sel:[0,0,0] op_sel_hi:[0,1,1]
    v_pk_fma_f32 v[96:97], v[234:235], v[96:97], v[196:197] op_sel:[0,0,0] op_sel_hi:[0,1,1]
    v_pk_fma_f32 v[98:99], v[234:235], v[98:99], v[198:199] op_sel:[0,0,0] op_sel_hi:[0,1,1]
    v_pk_mul_f32 v[192:193], v[92:93], v[92:93] op_sel:[0,0] op_sel_hi:[1,1]
    v_pk_mul_f32 v[194:195], v[94:95], v[94:95] op_sel:[0,0] op_sel_hi:[1,1]
    v_pk_mul_f32 v[196:197], v[96:97], v[96:97] op_sel:[0,0] op_sel_hi:[1,1]
    v_pk_mul_f32 v[198:199], v[98:99], v[98:99] op_sel:[0,0] op_sel_hi:[1,1]
    v_pk_fma_f32 v[192:193], v[192:193], s[100:101], v[250:251] op_sel:[0,0,0] op_sel_hi:[1,0,0]
    v_pk_fma_f32 v[194:195], v[194:195], s[100:101], v[250:251] op_sel:[0,0,0] op_sel_hi:[1,0,0]
    v_pk_fma_f32 v[196:197], v[196:197], s[100:101], v[250:251] op_sel:[0,0,0] op_sel_hi:[1,0,0]
    v_pk_fma_f32 v[198:199], v[198:199], s[100:101], v[250:251] op_sel:[0,0,0] op_sel_hi:[1,0,0]
    v_pk_mul_f32 v[192:193], v[192:193], v[92:93] op_sel:[0,0] op_sel_hi:[1,1]
    v_pk_mul_f32 v[194:195], v[194:195], v[94:95] op_sel:[0,0] op_sel_hi:[1,1]
    v_pk_mul_f32 v[196:197], v[196:197], v[96:97] op_sel:[0,0] op_sel_hi:[1,1]
    v_pk_mul_f32 v[198:199], v[198:199], v[98:99] op_sel:[0,0] op_sel_hi:[1,1]
    v_exp_f32 v192, v192
    v_exp_f32 v193, v193
    v_exp_f32 v194, v194
    v_exp_f32 v195, v195
    v_exp_f32 v196, v196
    v_exp_f32 v197, v197
    v_exp_f32 v198, v198
    v_exp_f32 v199, v199
    v_pk_add_f32 v[192:193], v[192:193], 1.0 op_sel:[0,0] op_sel_hi:[1,0]
    v_pk_add_f32 v[194:195], v[194:195], 1.0 op_sel:[0,0] op_sel_hi:[1,0]
    v_pk_add_f32 v[196:197], v[196:197], 1.0 op_sel:[0,0] op_sel_hi:[1,0]
    v_pk_add_f32 v[198:199], v[198:199], 1.0 op_sel:[0,0] op_sel_hi:[1,0]
    v_rcp_f32 v192, v192
    v_rcp_f32 v193, v193
    v_rcp_f32 v194, v194
    v_rcp_f32 v195, v195
    v_rcp_f32 v196, v196
    v_rcp_f32 v197, v197
    v_rcp_f32 v198, v198
    v_rcp_f32 v199, v199
    v_pk_mul_f32 v[192:193], v[192:193], v[92:93] op_sel:[0,0] op_sel_hi:[1,1]
    v_pk_mul_f32 v[194:195], v[194:195], v[94:95] op_sel:[0,0] op_sel_hi:[1,1]
    v_pk_mul_f32 v[196:197], v[196:197], v[96:97] op_sel:[0,0] op_sel_hi:[1,1]
    v_pk_mul_f32 v[198:199], v[198:199], v[98:99] op_sel:[0,0] op_sel_hi:[1,1]
    v_cvt_pk_bf16_f32 v136, v192, v193
    v_cvt_pk_bf16_f32 v137, v194, v195
    v_cvt_pk_bf16_f32 v140, v196, v197
    v_cvt_pk_bf16_f32 v141, v198, v199
    v_lshlrev_b32 v188, 16, v134
    v_and_b32 v189, s101, v134
    v_lshlrev_b32 v190, 16, v135
    v_and_b32 v191, s101, v135
    v_pk_fma_f32 v[192:193], v[232:233], v[128:129], v[188:189] op_sel:[0,0,0] op_sel_hi:[0,1,1]
    v_pk_fma_f32 v[194:195], v[232:233], v[130:131], v[190:191] op_sel:[0,0,0] op_sel_hi:[0,1,1]
    v_pk_fma_f32 v[196:197], v[236:237], v[128:129], v[188:189] op_sel:[0,0,0] op_sel_hi:[0,1,1]
    v_pk_fma_f32 v[198:199], v[236:237], v[130:131], v[190:191] op_sel:[0,0,0] op_sel_hi:[0,1,1]
    v_pk_fma_f32 v[108:109], v[230:231], v[108:109], v[192:193] op_sel:[0,0,0] op_sel_hi:[0,1,1]
    v_pk_fma_f32 v[110:111], v[230:231], v[110:111], v[194:195] op_sel:[0,0,0] op_sel_hi:[0,1,1]
    v_pk_fma_f32 v[112:113], v[234:235], v[112:113], v[196:197] op_sel:[0,0,0] op_sel_hi:[0,1,1]
    v_pk_fma_f32 v[114:115], v[234:235], v[114:115], v[198:199] op_sel:[0,0,0] op_sel_hi:[0,1,1]
    v_pk_mul_f32 v[192:193], v[108:109], v[108:109] op_sel:[0,0] op_sel_hi:[1,1]
    v_pk_mul_f32 v[194:195], v[110:111], v[110:111] op_sel:[0,0] op_sel_hi:[1,1]
    v_pk_mul_f32 v[196:197], v[112:113], v[112:113] op_sel:[0,0] op_sel_hi:[1,1]
    v_pk_mul_f32 v[198:199], v[114:115], v[114:115] op_sel:[0,0] op_sel_hi:[1,1]
    v_pk_fma_f32 v[192:193], v[192:193], s[100:101], v[250:251] op_sel:[0,0,0] op_sel_hi:[1,0,0]
    v_pk_fma_f32 v[194:195], v[194:195], s[100:101], v[250:251] op_sel:[0,0,0] op_sel_hi:[1,0,0]
    v_pk_fma_f32 v[196:197], v[196:197], s[100:101], v[250:251] op_sel:[0,0,0] op_sel_hi:[1,0,0]
    v_pk_fma_f32 v[198:199], v[198:199], s[100:101], v[250:251] op_sel:[0,0,0] op_sel_hi:[1,0,0]
    v_pk_mul_f32 v[192:193], v[192:193], v[108:109] op_sel:[0,0] op_sel_hi:[1,1]
    v_pk_mul_f32 v[194:195], v[194:195], v[110:111] op_sel:[0,0] op_sel_hi:[1,1]
    v_pk_mul_f32 v[196:197], v[196:197], v[112:113] op_sel:[0,0] op_sel_hi:[1,1]
    v_pk_mul_f32 v[198:199], v[198:199], v[114:115] op_sel:[0,0] op_sel_hi:[1,1]
    v_exp_f32 v192, v192
    v_exp_f32 v193, v193
    v_exp_f32 v194, v194
    v_exp_f32 v195, v195
    v_exp_f32 v196, v196
    v_exp_f32 v197, v197
    v_exp_f32 v198, v198
    v_exp_f32 v199, v199
    v_pk_add_f32 v[192:193], v[192:193], 1.0 op_sel:[0,0] op_sel_hi:[1,0]
    v_pk_add_f32 v[194:195], v[194:195], 1.0 op_sel:[0,0] op_sel_hi:[1,0]
    v_pk_add_f32 v[196:197], v[196:197], 1.0 op_sel:[0,0] op_sel_hi:[1,0]
    v_pk_add_f32 v[198:199], v[198:199], 1.0 op_sel:[0,0] op_sel_hi:[1,0]
    v_rcp_f32 v192, v192
    v_rcp_f32 v193, v193
    v_rcp_f32 v194, v194
    v_rcp_f32 v195, v195
    v_rcp_f32 v196, v196
    v_rcp_f32 v197, v197
    v_rcp_f32 v198, v198
    v_rcp_f32 v199, v199
    v_pk_mul_f32 v[192:193], v[192:193], v[108:109] op_sel:[0,0] op_sel_hi:[1,1]
    v_pk_mul_f32 v[194:195], v[194:195], v[110:111] op_sel:[0,0] op_sel_hi:[1,1]
    v_pk_mul_f32 v[196:197], v[196:197], v[112:113] op_sel:[0,0] op_sel_hi:[1,1]
    v_pk_mul_f32 v[198:199], v[198:199], v[114:115] op_sel:[0,0] op_sel_hi:[1,1]
    v_cvt_pk_bf16_f32 v138, v192, v193
    v_cvt_pk_bf16_f32 v139, v194, v195
    v_cvt_pk_bf16_f32 v142, v196, v197
    v_cvt_pk_bf16_f32 v143, v198, v199
    s_add_u32 s70, s76, 49152
    buffer_store_dwordx4 v[136:139], v2, s[44:47], s76 offen offset:0 sc1
    buffer_store_dwordx4 v[140:143], v2, s[44:47], s70 offen offset:0 sc1
    v_mov_b32 v4, 89092
    v_mov_b32 v5, 1
    s_mov_b64 exec, 1
    ds_add_u32 v4, v5
    s_mov_b64 exec, -1
    v_pk_fma_f32 v[192:193], v[240:241], v[124:125], v[184:185] op_sel:[0,0,0] op_sel_hi:[0,1,1]
    v_pk_fma_f32 v[194:195], v[240:241], v[126:127], v[186:187] op_sel:[0,0,0] op_sel_hi:[0,1,1]
    v_pk_fma_f32 v[196:197], v[244:245], v[124:125], v[184:185] op_sel:[0,0,0] op_sel_hi:[0,1,1]
    v_pk_fma_f32 v[198:199], v[244:245], v[126:127], v[186:187] op_sel:[0,0,0] op_sel_hi:[0,1,1]
    v_pk_fma_f32 v[100:101], v[238:239], v[100:101], v[192:193] op_sel:[0,0,0] op_sel_hi:[0,1,1]
    v_pk_fma_f32 v[102:103], v[238:239], v[102:103], v[194:195] op_sel:[0,0,0] op_sel_hi:[0,1,1]
    v_pk_fma_f32 v[104:105], v[242:243], v[104:105], v[196:197] op_sel:[0,0,0] op_sel_hi:[0,1,1]
    v_pk_fma_f32 v[106:107], v[242:243], v[106:107], v[198:199] op_sel:[0,0,0] op_sel_hi:[0,1,1]
    v_pk_mul_f32 v[192:193], v[100:101], v[100:101] op_sel:[0,0] op_sel_hi:[1,1]
    v_pk_mul_f32 v[194:195], v[102:103], v[102:103] op_sel:[0,0] op_sel_hi:[1,1]
    v_pk_mul_f32 v[196:197], v[104:105], v[104:105] op_sel:[0,0] op_sel_hi:[1,1]
    v_pk_mul_f32 v[198:199], v[106:107], v[106:107] op_sel:[0,0] op_sel_hi:[1,1]
    v_pk_fma_f32 v[192:193], v[192:193], s[100:101], v[250:251] op_sel:[0,0,0] op_sel_hi:[1,0,0]
    v_pk_fma_f32 v[194:195], v[194:195], s[100:101], v[250:251] op_sel:[0,0,0] op_sel_hi:[1,0,0]
    v_pk_fma_f32 v[196:197], v[196:197], s[100:101], v[250:251] op_sel:[0,0,0] op_sel_hi:[1,0,0]
    v_pk_fma_f32 v[198:199], v[198:199], s[100:101], v[250:251] op_sel:[0,0,0] op_sel_hi:[1,0,0]
    v_pk_mul_f32 v[192:193], v[192:193], v[100:101] op_sel:[0,0] op_sel_hi:[1,1]
    v_pk_mul_f32 v[194:195], v[194:195], v[102:103] op_sel:[0,0] op_sel_hi:[1,1]
    v_pk_mul_f32 v[196:197], v[196:197], v[104:105] op_sel:[0,0] op_sel_hi:[1,1]
    v_pk_mul_f32 v[198:199], v[198:199], v[106:107] op_sel:[0,0] op_sel_hi:[1,1]
    v_exp_f32 v192, v192
    v_exp_f32 v193, v193
    v_exp_f32 v194, v194
    v_exp_f32 v195, v195
    v_exp_f32 v196, v196
    v_exp_f32 v197, v197
    v_exp_f32 v198, v198
    v_exp_f32 v199, v199
    v_pk_add_f32 v[192:193], v[192:193], 1.0 op_sel:[0,0] op_sel_hi:[1,0]
    v_pk_add_f32 v[194:195], v[194:195], 1.0 op_sel:[0,0] op_sel_hi:[1,0]
    v_pk_add_f32 v[196:197], v[196:197], 1.0 op_sel:[0,0] op_sel_hi:[1,0]
    v_pk_add_f32 v[198:199], v[198:199], 1.0 op_sel:[0,0] op_sel_hi:[1,0]
    v_rcp_f32 v192, v192
    v_rcp_f32 v193, v193
    v_rcp_f32 v194, v194
    v_rcp_f32 v195, v195
    v_rcp_f32 v196, v196
    v_rcp_f32 v197, v197
    v_rcp_f32 v198, v198
    v_rcp_f32 v199, v199
    v_pk_mul_f32 v[192:193], v[192:193], v[100:101] op_sel:[0,0] op_sel_hi:[1,1]
    v_pk_mul_f32 v[194:195], v[194:195], v[102:103] op_sel:[0,0] op_sel_hi:[1,1]
    v_pk_mul_f32 v[196:197], v[196:197], v[104:105] op_sel:[0,0] op_sel_hi:[1,1]
    v_pk_mul_f32 v[198:199], v[198:199], v[106:107] op_sel:[0,0] op_sel_hi:[1,1]
    v_cvt_pk_bf16_f32 v144, v192, v193
    v_cvt_pk_bf16_f32 v145, v194, v195
    v_cvt_pk_bf16_f32 v148, v196, v197
    v_cvt_pk_bf16_f32 v149, v198, v199
    v_pk_fma_f32 v[192:193], v[240:241], v[128:129], v[188:189] op_sel:[0,0,0] op_sel_hi:[0,1,1]
    v_pk_fma_f32 v[194:195], v[240:241], v[130:131], v[190:191] op_sel:[0,0,0] op_sel_hi:[0,1,1]
    v_pk_fma_f32 v[196:197], v[244:245], v[128:129], v[188:189] op_sel:[0,0,0] op_sel_hi:[0,1,1]
    v_pk_fma_f32 v[198:199], v[244:245], v[130:131], v[190:191] op_sel:[0,0,0] op_sel_hi:[0,1,1]
    v_pk_fma_f32 v[116:117], v[238:239], v[116:117], v[192:193] op_sel:[0,0,0] op_sel_hi:[0,1,1]
    v_pk_fma_f32 v[118:119], v[238:239], v[118:119], v[194:195] op_sel:[0,0,0] op_sel_hi:[0,1,1]
    v_pk_fma_f32 v[120:121], v[242:243], v[120:121], v[196:197] op_sel:[0,0,0] op_sel_hi:[0,1,1]
    v_pk_fma_f32 v[122:123], v[242:243], v[122:123], v[198:199] op_sel:[0,0,0] op_sel_hi:[0,1,1]
    v_pk_mul_f32 v[192:193], v[116:117], v[116:117] op_sel:[0,0] op_sel_hi:[1,1]
    v_pk_mul_f32 v[194:195], v[118:119], v[118:119] op_sel:[0,0] op_sel_hi:[1,1]
    v_pk_mul_f32 v[196:197], v[120:121], v[120:121] op_sel:[0,0] op_sel_hi:[1,1]
    v_pk_mul_f32 v[198:199], v[122:123], v[122:123] op_sel:[0,0] op_sel_hi:[1,1]
    v_pk_fma_f32 v[192:193], v[192:193], s[100:101], v[250:251] op_sel:[0,0,0] op_sel_hi:[1,0,0]
    v_pk_fma_f32 v[194:195], v[194:195], s[100:101], v[250:251] op_sel:[0,0,0] op_sel_hi:[1,0,0]
    v_pk_fma_f32 v[196:197], v[196:197], s[100:101], v[250:251] op_sel:[0,0,0] op_sel_hi:[1,0,0]
    v_pk_fma_f32 v[198:199], v[198:199], s[100:101], v[250:251] op_sel:[0,0,0] op_sel_hi:[1,0,0]
    v_pk_mul_f32 v[192:193], v[192:193], v[116:117] op_sel:[0,0] op_sel_hi:[1,1]
    v_pk_mul_f32 v[194:195], v[194:195], v[118:119] op_sel:[0,0] op_sel_hi:[1,1]
    v_pk_mul_f32 v[196:197], v[196:197], v[120:121] op_sel:[0,0] op_sel_hi:[1,1]
    v_pk_mul_f32 v[198:199], v[198:199], v[122:123] op_sel:[0,0] op_sel_hi:[1,1]
    v_exp_f32 v192, v192
    v_exp_f32 v193, v193
    v_exp_f32 v194, v194
    v_exp_f32 v195, v195
    v_exp_f32 v196, v196
    v_exp_f32 v197, v197
    v_exp_f32 v198, v198
    v_exp_f32 v199, v199
    v_pk_add_f32 v[192:193], v[192:193], 1.0 op_sel:[0,0] op_sel_hi:[1,0]
    v_pk_add_f32 v[194:195], v[194:195], 1.0 op_sel:[0,0] op_sel_hi:[1,0]
    v_pk_add_f32 v[196:197], v[196:197], 1.0 op_sel:[0,0] op_sel_hi:[1,0]
    v_pk_add_f32 v[198:199], v[198:199], 1.0 op_sel:[0,0] op_sel_hi:[1,0]
    v_rcp_f32 v192, v192
    v_rcp_f32 v193, v193
    v_rcp_f32 v194, v194
    v_rcp_f32 v195, v195
    v_rcp_f32 v196, v196
    v_rcp_f32 v197, v197
    v_rcp_f32 v198, v198
    v_rcp_f32 v199, v199
    v_pk_mul_f32 v[192:193], v[192:193], v[116:117] op_sel:[0,0] op_sel_hi:[1,1]
    v_pk_mul_f32 v[194:195], v[194:195], v[118:119] op_sel:[0,0] op_sel_hi:[1,1]
    v_pk_mul_f32 v[196:197], v[196:197], v[120:121] op_sel:[0,0] op_sel_hi:[1,1]
    v_pk_mul_f32 v[198:199], v[198:199], v[122:123] op_sel:[0,0] op_sel_hi:[1,1]
    v_cvt_pk_bf16_f32 v146, v192, v193
    v_cvt_pk_bf16_f32 v147, v194, v195
    v_cvt_pk_bf16_f32 v150, v196, v197
    v_cvt_pk_bf16_f32 v151, v198, v199
    s_add_u32 s70, s77, 49152
    buffer_store_dwordx4 v[144:147], v2, s[44:47], s77 offen offset:0 sc1
    buffer_store_dwordx4 v[148:151], v2, s[44:47], s70 offen offset:0 sc1
    v_mov_b32 v4, 89096
    v_mov_b32 v5, 1
    s_mov_b64 exec, 1
    ds_add_u32 v4, v5
    s_mov_b64 exec, -1
    s_branch Lp2
Lp1_1:
    s_mov_b32 s86, 0xfffea000
    s_mov_b32 s87, 45056
    s_barrier
    ds_read_b128 v[124:127], v2 offset:0
    ds_read_b128 v[128:131], v2 offset:2048
    ds_read_b128 v[132:135], v4 offset:0
    ds_read_b128 v[136:139], v4 offset:2048
    ds_read_b64_tr_b16 v[140:141], v6 offset:0
    ds_read_b64_tr_b16 v[142:143], v6 offset:1280
    ds_read_b64_tr_b16 v[144:145], v6 offset:32
    ds_read_b64_tr_b16 v[146:147], v6 offset:1312
    ds_read_b64_tr_b16 v[148:149], v6 offset:64
    ds_read_b64_tr_b16 v[150:151], v6 offset:1344
    ds_read_b64_tr_b16 v[152:153], v7 offset:0
    ds_read_b64_tr_b16 v[154:155], v7 offset:2048
    ds_read_b64_tr_b16 v[156:157], v8 offset:0
    ds_read_b64_tr_b16 v[158:159], v8 offset:2048
    ds_read_b64_tr_b16 v[160:161], v9 offset:0
    ds_read_b64_tr_b16 v[162:163], v9 offset:2048
    ds_read_b64_tr_b16 v[164:165], v10 offset:0
    ds_read_b64_tr_b16 v[166:167], v10 offset:2048
    s_waitcnt lgkmcnt(0)
    s_branch Lret1_1
.p2align 3
Lp1h_1_1:
    s_barrier
    v_mfma_f32_16x16x32_bf16 v[12:15], v[184:187], v[168:171], v[12:15]
    v_mfma_f32_16x16x32_bf16 v[16:19], v[184:187], v[172:175], v[16:19]
    v_mfma_f32_16x16x32_bf16 v[20:23], v[184:187], v[176:179], v[20:23]
    ds_read_b128 v[124:127], v2 offset:0
    v_mfma_f32_16x16x32_bf16 v[24:27], v[184:187], v[180:183], v[24:27]
    ds_read_b128 v[128:131], v2 offset:2048
    v_mfma_f32_16x16x32_bf16 v[28:31], v[188:191], v[168:171], v[28:31]
    ds_read_b128 v[132:135], v4 offset:0
    v_mfma_f32_16x16x32_bf16 v[32:35], v[188:191], v[172:175], v[32:35]
    ds_read_b128 v[136:139], v4 offset:2048
    v_mfma_f32_16x16x32_bf16 v[36:39], v[188:191], v[176:179], v[36:39]
    ds_read_b64_tr_b16 v[140:141], v6 offset:0
    v_mfma_f32_16x16x32_bf16 v[40:43], v[188:191], v[180:183], v[40:43]
    ds_read_b64_tr_b16 v[142:143], v6 offset:1280
    v_mfma_f32_16x16x32_bf16 v[44:47], v[192:195], v[168:171], v[44:47]
    ds_read_b64_tr_b16 v[144:145], v6 offset:32
    v_mfma_f32_16x16x32_bf16 v[48:51], v[192:195], v[172:175], v[48:51]
    ds_read_b64_tr_b16 v[146:147], v6 offset:1312
    v_mfma_f32_16x16x32_bf16 v[52:55], v[192:195], v[176:179], v[52:55]
    ds_read_b64_tr_b16 v[148:149], v6 offset:64
    v_mfma_f32_16x16x32_bf16 v[56:59], v[192:195], v[180:183], v[56:59]
    ds_read_b64_tr_b16 v[150:151], v6 offset:1344
    v_mfma_f32_16x16x32_bf16 v[60:63], v[196:199], v[168:171], v[60:63]
    ds_read_b64_tr_b16 v[152:153], v7 offset:0
    v_mfma_f32_16x16x32_bf16 v[64:67], v[196:199], v[172:175], v[64:67]
    ds_read_b64_tr_b16 v[154:155], v7 offset:2048
    v_mfma_f32_16x16x32_bf16 v[68:71], v[196:199], v[176:179], v[68:71]
    ds_read_b64_tr_b16 v[156:157], v8 offset:0
    v_mfma_f32_16x16x32_bf16 v[72:75], v[196:199], v[180:183], v[72:75]
    ds_read_b64_tr_b16 v[158:159], v8 offset:2048
    v_mfma_f32_16x16x32_bf16 v[76:79], v[200:203], v[168:171], v[76:79]
    ds_read_b64_tr_b16 v[160:161], v9 offset:0
    v_mfma_f32_16x16x32_bf16 v[80:83], v[200:203], v[172:175], v[80:83]
    ds_read_b64_tr_b16 v[162:163], v9 offset:2048
    v_mfma_f32_16x16x32_bf16 v[84:87], v[200:203], v[176:179], v[84:87]
    ds_read_b64_tr_b16 v[164:165], v10 offset:0
    v_mfma_f32_16x16x32_bf16 v[88:91], v[200:203], v[180:183], v[88:91]
    ds_read_b64_tr_b16 v[166:167], v10 offset:2048
    v_mfma_f32_16x16x32_bf16 v[92:95], v[204:207], v[168:171], v[92:95]
    v_mfma_f32_16x16x32_bf16 v[96:99], v[204:207], v[172:175], v[96:99]
    v_mfma_f32_16x16x32_bf16 v[100:103], v[204:207], v[176:179], v[100:103]
    v_mfma_f32_16x16x32_bf16 v[104:107], v[204:207], v[180:183], v[104:107]
    v_mfma_f32_16x16x32_bf16 v[108:111], v[208:211], v[168:171], v[108:111]
    v_mfma_f32_16x16x32_bf16 v[112:115], v[208:211], v[172:175], v[112:115]
    s_bitcmp1_b32 s10, s83
    v_mfma_f32_16x16x32_bf16 v[116:119], v[208:211], v[176:179], v[116:119]
    v_mfma_f32_16x16x32_bf16 v[120:123], v[208:211], v[180:183], v[120:123]
    s_cbranch_scc1 Lx1
Lret1_1:
    s_waitcnt lgkmcnt(0)
    v_mfma_f32_16x16x32_bf16 v[12:15], v[140:143], v[124:127], v[12:15]
    s_add_u32 s83, s83, 1
    ds_read_b128 v[168:171], v3 offset:0
    v_mfma_f32_16x16x32_bf16 v[16:19], v[140:143], v[128:131], v[16:19]
    s_bitcmp1_b32 0x248, s83
    ds_read_b128 v[172:175], v3 offset:2048
    v_mfma_f32_16x16x32_bf16 v[20:23], v[140:143], v[132:135], v[20:23]
    s_cselect_b32 s82, s86, s87
    ds_read_b128 v[176:179], v5 offset:0
    v_mfma_f32_16x16x32_bf16 v[24:27], v[140:143], v[136:139], v[24:27]
    ds_read_b128 v[180:183], v5 offset:2048
    v_mfma_f32_16x16x32_bf16 v[28:31], v[144:147], v[124:127], v[28:31]
    ds_read_b64_tr_b16 v[184:185], v6 offset:5120
    v_mfma_f32_16x16x32_bf16 v[32:35], v[144:147], v[128:131], v[32:35]
    ds_read_b64_tr_b16 v[186:187], v6 offset:6400
    v_mfma_f32_16x16x32_bf16 v[36:39], v[144:147], v[132:135], v[36:39]
    ds_read_b64_tr_b16 v[188:189], v6 offset:5152
    v_mfma_f32_16x16x32_bf16 v[40:43], v[144:147], v[136:139], v[40:43]
    ds_read_b64_tr_b16 v[190:191], v6 offset:6432
    v_mfma_f32_16x16x32_bf16 v[44:47], v[148:151], v[124:127], v[44:47]
    ds_read_b64_tr_b16 v[192:193], v6 offset:5184
    v_mfma_f32_16x16x32_bf16 v[48:51], v[148:151], v[128:131], v[48:51]
    ds_read_b64_tr_b16 v[194:195], v6 offset:6464
    v_mfma_f32_16x16x32_bf16 v[52:55], v[148:151], v[132:135], v[52:55]
    ds_read_b64_tr_b16 v[196:197], v7 offset:8192
    v_mfma_f32_16x16x32_bf16 v[56:59], v[148:151], v[136:139], v[56:59]
    ds_read_b64_tr_b16 v[198:199], v7 offset:10240
    v_mfma_f32_16x16x32_bf16 v[60:63], v[152:155], v[124:127], v[60:63]
    ds_read_b64_tr_b16 v[200:201], v8 offset:8192
    v_mfma_f32_16x16x32_bf16 v[64:67], v[152:155], v[128:131], v[64:67]
    ds_read_b64_tr_b16 v[202:203], v8 offset:10240
    v_mfma_f32_16x16x32_bf16 v[68:71], v[152:155], v[132:135], v[68:71]
    ds_read_b64_tr_b16 v[204:205], v9 offset:8192
    v_mfma_f32_16x16x32_bf16 v[72:75], v[152:155], v[136:139], v[72:75]
    ds_read_b64_tr_b16 v[206:207], v9 offset:10240
    v_mfma_f32_16x16x32_bf16 v[76:79], v[156:159], v[124:127], v[76:79]
    ds_read_b64_tr_b16 v[208:209], v10 offset:8192
    v_mfma_f32_16x16x32_bf16 v[80:83], v[156:159], v[128:131], v[80:83]
    ds_read_b64_tr_b16 v[210:211], v10 offset:10240
    v_mfma_f32_16x16x32_bf16 v[84:87], v[156:159], v[132:135], v[84:87]
    v_add_u32 v2, s82, v2
    v_add_u32 v3, s82, v3
    v_mfma_f32_16x16x32_bf16 v[88:91], v[156:159], v[136:139], v[88:91]
    v_add_u32 v4, s82, v4
    v_add_u32 v5, s82, v5
    v_mfma_f32_16x16x32_bf16 v[92:95], v[160:163], v[124:127], v[92:95]
    v_add_u32 v6, s82, v6
    v_add_u32 v7, s82, v7
    v_mfma_f32_16x16x32_bf16 v[96:99], v[160:163], v[128:131], v[96:99]
    v_add_u32 v8, s82, v8
    v_add_u32 v9, s82, v9
    v_mfma_f32_16x16x32_bf16 v[100:103], v[160:163], v[132:135], v[100:103]
    v_add_u32 v10, s82, v10
    v_mfma_f32_16x16x32_bf16 v[104:107], v[160:163], v[136:139], v[104:107]
    v_mfma_f32_16x16x32_bf16 v[108:111], v[164:167], v[124:127], v[108:111]
    v_mfma_f32_16x16x32_bf16 v[112:115], v[164:167], v[128:131], v[112:115]
    s_bitcmp0_b32 0x28, s83
    s_cbranch_scc1 Lvw_88
    s_waitcnt vmcnt(0)
Lvw_88:
    s_bitcmp1_b32 s11, s83
    s_cbranch_scc1 Lx0
Lret0_1:
    v_mfma_f32_16x16x32_bf16 v[116:119], v[164:167], v[132:135], v[116:119]
    s_cmp_lt_u32 s83, 5
    v_mfma_f32_16x16x32_bf16 v[120:123], v[164:167], v[136:139], v[120:123]
    s_waitcnt lgkmcnt(0)
    s_cbranch_scc1 Lp1h_1_1
.p2align 3
Lp1h_1_0:
    s_barrier
    v_mfma_f32_16x16x32_bf16 v[12:15], v[184:187], v[168:171], v[12:15]
    v_mfma_f32_16x16x32_bf16 v[16:19], v[184:187], v[172:175], v[16:19]
    v_mfma_f32_16x16x32_bf16 v[20:23], v[184:187], v[176:179], v[20:23]
    ds_read_b128 v[124:127], v2 offset:0
    v_mfma_f32_16x16x32_bf16 v[24:27], v[184:187], v[180:183], v[24:27]
    ds_read_b128 v[128:131], v2 offset:2048
    v_mfma_f32_16x16x32_bf16 v[28:31], v[188:191], v[168:171], v[28:31]
    ds_read_b128 v[132:135], v4 offset:0
    v_mfma_f32_16x16x32_bf16 v[32:35], v[188:191], v[172:175], v[32:35]
    ds_read_b128 v[136:139], v4 offset:2048
    v_mfma_f32_16x16x32_bf16 v[36:39], v[188:191], v[176:179], v[36:39]
    ds_read_b64_tr_b16 v[140:141], v6 offset:0
    v_mfma_f32_16x16x32_bf16 v[40:43], v[188:191], v[180:183], v[40:43]
    ds_read_b64_tr_b16 v[142:143], v6 offset:1280
    v_mfma_f32_16x16x32_bf16 v[44:47], v[192:195], v[168:171], v[44:47]
    ds_read_b64_tr_b16 v[144:145], v6 offset:32
    v_mfma_f32_16x16x32_bf16 v[48:51], v[192:195], v[172:175], v[48:51]
    ds_read_b64_tr_b16 v[146:147], v6 offset:1312
    v_mfma_f32_16x16x32_bf16 v[52:55], v[192:195], v[176:179], v[52:55]
    ds_read_b64_tr_b16 v[148:149], v6 offset:64
    v_mfma_f32_16x16x32_bf16 v[56:59], v[192:195], v[180:183], v[56:59]
    ds_read_b64_tr_b16 v[150:151], v6 offset:1344
    v_mfma_f32_16x16x32_bf16 v[60:63], v[196:199], v[168:171], v[60:63]
    ds_read_b64_tr_b16 v[152:153], v7 offset:0
    v_mfma_f32_16x16x32_bf16 v[64:67], v[196:199], v[172:175], v[64:67]
    ds_read_b64_tr_b16 v[154:155], v7 offset:2048
    v_mfma_f32_16x16x32_bf16 v[68:71], v[196:199], v[176:179], v[68:71]
    ds_read_b64_tr_b16 v[156:157], v8 offset:0
    v_mfma_f32_16x16x32_bf16 v[72:75], v[196:199], v[180:183], v[72:75]
    ds_read_b64_tr_b16 v[158:159], v8 offset:2048
    v_mfma_f32_16x16x32_bf16 v[76:79], v[200:203], v[168:171], v[76:79]
    ds_read_b64_tr_b16 v[160:161], v9 offset:0
    v_mfma_f32_16x16x32_bf16 v[80:83], v[200:203], v[172:175], v[80:83]
    ds_read_b64_tr_b16 v[162:163], v9 offset:2048
    v_mfma_f32_16x16x32_bf16 v[84:87], v[200:203], v[176:179], v[84:87]
    ds_read_b64_tr_b16 v[164:165], v10 offset:0
    v_mfma_f32_16x16x32_bf16 v[88:91], v[200:203], v[180:183], v[88:91]
    ds_read_b64_tr_b16 v[166:167], v10 offset:2048
    v_mfma_f32_16x16x32_bf16 v[92:95], v[204:207], v[168:171], v[92:95]
    v_mfma_f32_16x16x32_bf16 v[96:99], v[204:207], v[172:175], v[96:99]
    v_mfma_f32_16x16x32_bf16 v[100:103], v[204:207], v[176:179], v[100:103]
    v_mfma_f32_16x16x32_bf16 v[104:107], v[204:207], v[180:183], v[104:107]
    v_mfma_f32_16x16x32_bf16 v[108:111], v[208:211], v[168:171], v[108:111]
    v_mfma_f32_16x16x32_bf16 v[112:115], v[208:211], v[172:175], v[112:115]
    v_mfma_f32_16x16x32_bf16 v[116:119], v[208:211], v[176:179], v[116:119]
    v_mfma_f32_16x16x32_bf16 v[120:123], v[208:211], v[180:183], v[120:123]
    s_waitcnt lgkmcnt(0)
    v_mfma_f32_16x16x32_bf16 v[12:15], v[140:143], v[124:127], v[12:15]
    s_add_u32 s83, s83, 1
    ds_read_b128 v[168:171], v3 offset:0
    v_mfma_f32_16x16x32_bf16 v[16:19], v[140:143], v[128:131], v[16:19]
    s_bitcmp1_b32 0x248, s83
    ds_read_b128 v[172:175], v3 offset:2048
    v_mfma_f32_16x16x32_bf16 v[20:23], v[140:143], v[132:135], v[20:23]
    s_cselect_b32 s82, s86, s87
    ds_read_b128 v[176:179], v5 offset:0
    v_mfma_f32_16x16x32_bf16 v[24:27], v[140:143], v[136:139], v[24:27]
    ds_read_b128 v[180:183], v5 offset:2048
    v_mfma_f32_16x16x32_bf16 v[28:31], v[144:147], v[124:127], v[28:31]
    ds_read_b64_tr_b16 v[184:185], v6 offset:5120
    v_mfma_f32_16x16x32_bf16 v[32:35], v[144:147], v[128:131], v[32:35]
    ds_read_b64_tr_b16 v[186:187], v6 offset:6400
    v_mfma_f32_16x16x32_bf16 v[36:39], v[144:147], v[132:135], v[36:39]
    ds_read_b64_tr_b16 v[188:189], v6 offset:5152
    v_mfma_f32_16x16x32_bf16 v[40:43], v[144:147], v[136:139], v[40:43]
    ds_read_b64_tr_b16 v[190:191], v6 offset:6432
    v_mfma_f32_16x16x32_bf16 v[44:47], v[148:151], v[124:127], v[44:47]
    ds_read_b64_tr_b16 v[192:193], v6 offset:5184
    v_mfma_f32_16x16x32_bf16 v[48:51], v[148:151], v[128:131], v[48:51]
    ds_read_b64_tr_b16 v[194:195], v6 offset:6464
    v_mfma_f32_16x16x32_bf16 v[52:55], v[148:151], v[132:135], v[52:55]
    ds_read_b64_tr_b16 v[196:197], v7 offset:8192
    v_mfma_f32_16x16x32_bf16 v[56:59], v[148:151], v[136:139], v[56:59]
    ds_read_b64_tr_b16 v[198:199], v7 offset:10240
    v_mfma_f32_16x16x32_bf16 v[60:63], v[152:155], v[124:127], v[60:63]
    ds_read_b64_tr_b16 v[200:201], v8 offset:8192
    v_mfma_f32_16x16x32_bf16 v[64:67], v[152:155], v[128:131], v[64:67]
    ds_read_b64_tr_b16 v[202:203], v8 offset:10240
    v_mfma_f32_16x16x32_bf16 v[68:71], v[152:155], v[132:135], v[68:71]
    ds_read_b64_tr_b16 v[204:205], v9 offset:8192
    v_mfma_f32_16x16x32_bf16 v[72:75], v[152:155], v[136:139], v[72:75]
    ds_read_b64_tr_b16 v[206:207], v9 offset:10240
    v_mfma_f32_16x16x32_bf16 v[76:79], v[156:159], v[124:127], v[76:79]
    ds_read_b64_tr_b16 v[208:209], v10 offset:8192
    v_mfma_f32_16x16x32_bf16 v[80:83], v[156:159], v[128:131], v[80:83]
    ds_read_b64_tr_b16 v[210:211], v10 offset:10240
    v_mfma_f32_16x16x32_bf16 v[84:87], v[156:159], v[132:135], v[84:87]
    v_add_u32 v2, s82, v2
    v_add_u32 v3, s82, v3
    v_mfma_f32_16x16x32_bf16 v[88:91], v[156:159], v[136:139], v[88:91]
    v_add_u32 v4, s82, v4
    v_add_u32 v5, s82, v5
    v_mfma_f32_16x16x32_bf16 v[92:95], v[160:163], v[124:127], v[92:95]
    v_add_u32 v6, s82, v6
    v_add_u32 v7, s82, v7
    v_mfma_f32_16x16x32_bf16 v[96:99], v[160:163], v[128:131], v[96:99]
    v_add_u32 v8, s82, v8
    v_add_u32 v9, s82, v9
    v_mfma_f32_16x16x32_bf16 v[100:103], v[160:163], v[132:135], v[100:103]
    v_add_u32 v10, s82, v10
    v_mfma_f32_16x16x32_bf16 v[104:107], v[160:163], v[136:139], v[104:107]
    v_mfma_f32_16x16x32_bf16 v[108:111], v[164:167], v[124:127], v[108:111]
    v_mfma_f32_16x16x32_bf16 v[112:115], v[164:167], v[128:131], v[112:115]
    v_mfma_f32_16x16x32_bf16 v[116:119], v[164:167], v[132:135], v[116:119]
    s_cmp_lt_u32 s83, 10
    v_mfma_f32_16x16x32_bf16 v[120:123], v[164:167], v[136:139], v[120:123]
    s_waitcnt lgkmcnt(0)
    s_cbranch_scc1 Lp1h_1_0
    s_barrier
    s_setprio 2
    s_mul_i32 s70, s69, 448
    s_add_u32 s70, s70, 88064
    v_lshl_add_u32 v5, v249, 4, s70
    v_xor_b32 v6, 128, v251
    s_lshl_b32 s70, s69, 7
    s_add_u32 s70, s70, 163328
    v_lshl_add_u32 v7, v249, 3, s70
    v_lshlrev_b32 v2, 4, v1
    s_mov_b32 s100, 0xbdd2d3e8
    s_mov_b32 s101, 0xffff0000
    v_mov_b32 v250, 0xc0135761
    ds_read_b32 v216, v251 offset:1024
    ds_read_b32 v218, v251 offset:1536
    ds_read_b32 v220, v251 offset:1088
    ds_read_b32 v222, v251 offset:1600
    v_mfma_f32_16x16x32_bf16 v[60:63], v[196:199], v[168:171], v[60:63]
    ds_read_b32 v224, v6 offset:1024
    ds_read_b32 v226, v6 offset:1536
    v_mfma_f32_16x16x32_bf16 v[64:67], v[196:199], v[172:175], v[64:67]
    ds_read_b32 v228, v6 offset:1088
    v_mfma_f32_16x16x32_bf16 v[68:71], v[196:199], v[176:179], v[68:71]
    ds_read_b32 v230, v6 offset:1600
    v_mfma_f32_16x16x32_bf16 v[72:75], v[196:199], v[180:183], v[72:75]
    ds_read_b128 v[136:139], v5 offset:192
    ds_read_b64 v[152:153], v7 offset:0
    v_mfma_f32_16x16x32_bf16 v[76:79], v[200:203], v[168:171], v[76:79]
    ds_read_b128 v[140:143], v5 offset:256
    v_mfma_f32_16x16x32_bf16 v[80:83], v[200:203], v[172:175], v[80:83]
    ds_read_b64 v[154:155], v7 offset:32
    v_mfma_f32_16x16x32_bf16 v[84:87], v[200:203], v[176:179], v[84:87]
    v_mfma_f32_16x16x32_bf16 v[88:91], v[200:203], v[180:183], v[88:91]
    s_waitcnt lgkmcnt(0)
    v_lshlrev_b32 v196, 16, v152
    v_and_b32 v197, s101, v152
    v_lshlrev_b32 v198, 16, v153
    v_and_b32 v199, s101, v153
    v_pk_fma_f32 v[160:161], v[218:219], v[136:137], v[196:197] op_sel:[0,0,0] op_sel_hi:[0,1,1]
    v_pk_fma_f32 v[162:163], v[218:219], v[138:139], v[198:199] op_sel:[0,0,0] op_sel_hi:[0,1,1]
    v_pk_fma_f32 v[164:165], v[222:223], v[136:137], v[196:197] op_sel:[0,0,0] op_sel_hi:[0,1,1]
    v_pk_fma_f32 v[166:167], v[222:223], v[138:139], v[198:199] op_sel:[0,0,0] op_sel_hi:[0,1,1]
    v_pk_fma_f32 v[60:61], v[216:217], v[60:61], v[160:161] op_sel:[0,0,0] op_sel_hi:[0,1,1]
    v_pk_fma_f32 v[62:63], v[216:217], v[62:63], v[162:163] op_sel:[0,0,0] op_sel_hi:[0,1,1]
    v_pk_fma_f32 v[64:65], v[220:221], v[64:65], v[164:165] op_sel:[0,0,0] op_sel_hi:[0,1,1]
    v_pk_fma_f32 v[66:67], v[220:221], v[66:67], v[166:167] op_sel:[0,0,0] op_sel_hi:[0,1,1]
    v_pk_mul_f32 v[160:161], v[60:61], v[60:61] op_sel:[0,0] op_sel_hi:[1,1]
    v_pk_mul_f32 v[162:163], v[62:63], v[62:63] op_sel:[0,0] op_sel_hi:[1,1]
    v_pk_mul_f32 v[164:165], v[64:65], v[64:65] op_sel:[0,0] op_sel_hi:[1,1]
    v_pk_mul_f32 v[166:167], v[66:67], v[66:67] op_sel:[0,0] op_sel_hi:[1,1]
    v_pk_fma_f32 v[160:161], v[160:161], s[100:101], v[250:251] op_sel:[0,0,0] op_sel_hi:[1,0,0]
    v_pk_fma_f32 v[162:163], v[162:163], s[100:101], v[250:251] op_sel:[0,0,0] op_sel_hi:[1,0,0]
    v_pk_fma_f32 v[164:165], v[164:165], s[100:101], v[250:251] op_sel:[0,0,0] op_sel_hi:[1,0,0]
    v_pk_fma_f32 v[166:167], v[166:167], s[100:101], v[250:251] op_sel:[0,0,0] op_sel_hi:[1,0,0]
    v_pk_mul_f32 v[160:161], v[160:161], v[60:61] op_sel:[0,0] op_sel_hi:[1,1]
    v_pk_mul_f32 v[162:163], v[162:163], v[62:63] op_sel:[0,0] op_sel_hi:[1,1]
    v_pk_mul_f32 v[164:165], v[164:165], v[64:65] op_sel:[0,0] op_sel_hi:[1,1]
    v_pk_mul_f32 v[166:167], v[166:167], v[66:67] op_sel:[0,0] op_sel_hi:[1,1]
    v_exp_f32 v160, v160
    v_exp_f32 v161, v161
    v_exp_f32 v162, v162
    v_exp_f32 v163, v163
    v_exp_f32 v164, v164
    v_exp_f32 v165, v165
    v_exp_f32 v166, v166
    v_exp_f32 v167, v167
    v_pk_add_f32 v[160:161], v[160:161], 1.0 op_sel:[0,0] op_sel_hi:[1,0]
    v_pk_add_f32 v[162:163], v[162:163], 1.0 op_sel:[0,0] op_sel_hi:[1,0]
    v_pk_add_f32 v[164:165], v[164:165], 1.0 op_sel:[0,0] op_sel_hi:[1,0]
    v_pk_add_f32 v[166:167], v[166:167], 1.0 op_sel:[0,0] op_sel_hi:[1,0]
    v_rcp_f32 v160, v160
    v_rcp_f32 v161, v161
    v_rcp_f32 v162, v162
    v_rcp_f32 v163, v163
    v_rcp_f32 v164, v164
    v_rcp_f32 v165, v165
    v_rcp_f32 v166, v166
    v_rcp_f32 v167, v167
    v_pk_mul_f32 v[160:161], v[160:161], v[60:61] op_sel:[0,0] op_sel_hi:[1,1]
    v_pk_mul_f32 v[162:163], v[162:163], v[62:63] op_sel:[0,0] op_sel_hi:[1,1]
    v_pk_mul_f32 v[164:165], v[164:165], v[64:65] op_sel:[0,0] op_sel_hi:[1,1]
    v_pk_mul_f32 v[166:167], v[166:167], v[66:67] op_sel:[0,0] op_sel_hi:[1,1]
    v_cvt_pk_bf16_f32 v60, v160, v161
    v_cvt_pk_bf16_f32 v61, v162, v163
    v_cvt_pk_bf16_f32 v64, v164, v165
    v_cvt_pk_bf16_f32 v65, v166, v167
    v_lshlrev_b32 v200, 16, v154
    v_and_b32 v201, s101, v154
    v_lshlrev_b32 v202, 16, v155
    v_and_b32 v203, s101, v155
    v_pk_fma_f32 v[160:161], v[218:219], v[140:141], v[200:201] op_sel:[0,0,0] op_sel_hi:[0,1,1]
    v_pk_fma_f32 v[162:163], v[218:219], v[142:143], v[202:203] op_sel:[0,0,0] op_sel_hi:[0,1,1]
    v_pk_fma_f32 v[164:165], v[222:223], v[140:141], v[200:201] op_sel:[0,0,0] op_sel_hi:[0,1,1]
    v_pk_fma_f32 v[166:167], v[222:223], v[142:143], v[202:203] op_sel:[0,0,0] op_sel_hi:[0,1,1]
    v_pk_fma_f32 v[76:77], v[216:217], v[76:77], v[160:161] op_sel:[0,0,0] op_sel_hi:[0,1,1]
    v_pk_fma_f32 v[78:79], v[216:217], v[78:79], v[162:163] op_sel:[0,0,0] op_sel_hi:[0,1,1]
    v_pk_fma_f32 v[80:81], v[220:221], v[80:81], v[164:165] op_sel:[0,0,0] op_sel_hi:[0,1,1]
    v_pk_fma_f32 v[82:83], v[220:221], v[82:83], v[166:167] op_sel:[0,0,0] op_sel_hi:[0,1,1]
    v_pk_mul_f32 v[160:161], v[76:77], v[76:77] op_sel:[0,0] op_sel_hi:[1,1]
    v_pk_mul_f32 v[162:163], v[78:79], v[78:79] op_sel:[0,0] op_sel_hi:[1,1]
    v_pk_mul_f32 v[164:165], v[80:81], v[80:81] op_sel:[0,0] op_sel_hi:[1,1]
    v_pk_mul_f32 v[166:167], v[82:83], v[82:83] op_sel:[0,0] op_sel_hi:[1,1]
    v_pk_fma_f32 v[160:161], v[160:161], s[100:101], v[250:251] op_sel:[0,0,0] op_sel_hi:[1,0,0]
    v_pk_fma_f32 v[162:163], v[162:163], s[100:101], v[250:251] op_sel:[0,0,0] op_sel_hi:[1,0,0]
    v_pk_fma_f32 v[164:165], v[164:165], s[100:101], v[250:251] op_sel:[0,0,0] op_sel_hi:[1,0,0]
    v_pk_fma_f32 v[166:167], v[166:167], s[100:101], v[250:251] op_sel:[0,0,0] op_sel_hi:[1,0,0]
    v_pk_mul_f32 v[160:161], v[160:161], v[76:77] op_sel:[0,0] op_sel_hi:[1,1]
    v_pk_mul_f32 v[162:163], v[162:163], v[78:79] op_sel:[0,0] op_sel_hi:[1,1]
    v_pk_mul_f32 v[164:165], v[164:165], v[80:81] op_sel:[0,0] op_sel_hi:[1,1]
    v_pk_mul_f32 v[166:167], v[166:167], v[82:83] op_sel:[0,0] op_sel_hi:[1,1]
    v_exp_f32 v160, v160
    v_exp_f32 v161, v161
    v_exp_f32 v162, v162
    v_exp_f32 v163, v163
    v_exp_f32 v164, v164
    v_exp_f32 v165, v165
    v_exp_f32 v166, v166
    v_exp_f32 v167, v167
    v_pk_add_f32 v[160:161], v[160:161], 1.0 op_sel:[0,0] op_sel_hi:[1,0]
    v_pk_add_f32 v[162:163], v[162:163], 1.0 op_sel:[0,0] op_sel_hi:[1,0]
    v_pk_add_f32 v[164:165], v[164:165], 1.0 op_sel:[0,0] op_sel_hi:[1,0]
    v_pk_add_f32 v[166:167], v[166:167], 1.0 op_sel:[0,0] op_sel_hi:[1,0]
    v_rcp_f32 v160, v160
    v_rcp_f32 v161, v161
    v_rcp_f32 v162, v162
    v_rcp_f32 v163, v163
    v_rcp_f32 v164, v164
    v_rcp_f32 v165, v165
    v_rcp_f32 v166, v166
    v_rcp_f32 v167, v167
    v_pk_mul_f32 v[160:161], v[160:161], v[76:77] op_sel:[0,0] op_sel_hi:[1,1]
    v_pk_mul_f32 v[162:163], v[162:163], v[78:79] op_sel:[0,0] op_sel_hi:[1,1]
    v_pk_mul_f32 v[164:165], v[164:165], v[80:81] op_sel:[0,0] op_sel_hi:[1,1]
    v_pk_mul_f32 v[166:167], v[166:167], v[82:83] op_sel:[0,0] op_sel_hi:[1,1]
    v_cvt_pk_bf16_f32 v62, v160, v161
    v_cvt_pk_bf16_f32 v63, v162, v163
    v_cvt_pk_bf16_f32 v66, v164, v165
    v_cvt_pk_bf16_f32 v67, v166, v167
    s_add_u32 s70, s76, 49152
    buffer_store_dwordx4 v[60:63], v2, s[44:47], s76 offen offset:0 sc1
    buffer_store_dwordx4 v[64:67], v2, s[44:47], s70 offen offset:0 sc1
    v_pk_fma_f32 v[160:161], v[226:227], v[136:137], v[196:197] op_sel:[0,0,0] op_sel_hi:[0,1,1]
    v_pk_fma_f32 v[162:163], v[226:227], v[138:139], v[198:199] op_sel:[0,0,0] op_sel_hi:[0,1,1]
    v_pk_fma_f32 v[164:165], v[230:231], v[136:137], v[196:197] op_sel:[0,0,0] op_sel_hi:[0,1,1]
    v_pk_fma_f32 v[166:167], v[230:231], v[138:139], v[198:199] op_sel:[0,0,0] op_sel_hi:[0,1,1]
    v_pk_fma_f32 v[68:69], v[224:225], v[68:69], v[160:161] op_sel:[0,0,0] op_sel_hi:[0,1,1]
    v_pk_fma_f32 v[70:71], v[224:225], v[70:71], v[162:163] op_sel:[0,0,0] op_sel_hi:[0,1,1]
    v_pk_fma_f32 v[72:73], v[228:229], v[72:73], v[164:165] op_sel:[0,0,0] op_sel_hi:[0,1,1]
    v_pk_fma_f32 v[74:75], v[228:229], v[74:75], v[166:167] op_sel:[0,0,0] op_sel_hi:[0,1,1]
    v_pk_mul_f32 v[160:161], v[68:69], v[68:69] op_sel:[0,0] op_sel_hi:[1,1]
    v_pk_mul_f32 v[162:163], v[70:71], v[70:71] op_sel:[0,0] op_sel_hi:[1,1]
    v_pk_mul_f32 v[164:165], v[72:73], v[72:73] op_sel:[0,0] op_sel_hi:[1,1]
    v_pk_mul_f32 v[166:167], v[74:75], v[74:75] op_sel:[0,0] op_sel_hi:[1,1]
    v_pk_fma_f32 v[160:161], v[160:161], s[100:101], v[250:251] op_sel:[0,0,0] op_sel_hi:[1,0,0]
    v_pk_fma_f32 v[162:163], v[162:163], s[100:101], v[250:251] op_sel:[0,0,0] op_sel_hi:[1,0,0]
    v_pk_fma_f32 v[164:165], v[164:165], s[100:101], v[250:251] op_sel:[0,0,0] op_sel_hi:[1,0,0]
    v_pk_fma_f32 v[166:167], v[166:167], s[100:101], v[250:251] op_sel:[0,0,0] op_sel_hi:[1,0,0]
    v_pk_mul_f32 v[160:161], v[160:161], v[68:69] op_sel:[0,0] op_sel_hi:[1,1]
    v_pk_mul_f32 v[162:163], v[162:163], v[70:71] op_sel:[0,0] op_sel_hi:[1,1]
    v_pk_mul_f32 v[164:165], v[164:165], v[72:73] op_sel:[0,0] op_sel_hi:[1,1]
    v_pk_mul_f32 v[166:167], v[166:167], v[74:75] op_sel:[0,0] op_sel_hi:[1,1]
    v_exp_f32 v160, v160
    v_exp_f32 v161, v161
    v_exp_f32 v162, v162
    v_exp_f32 v163, v163
    v_exp_f32 v164, v164
    v_exp_f32 v165, v165
    v_exp_f32 v166, v166
    v_exp_f32 v167, v167
    v_pk_add_f32 v[160:161], v[160:161], 1.0 op_sel:[0,0] op_sel_hi:[1,0]
    v_pk_add_f32 v[162:163], v[162:163], 1.0 op_sel:[0,0] op_sel_hi:[1,0]
    v_pk_add_f32 v[164:165], v[164:165], 1.0 op_sel:[0,0] op_sel_hi:[1,0]
    v_pk_add_f32 v[166:167], v[166:167], 1.0 op_sel:[0,0] op_sel_hi:[1,0]
    v_rcp_f32 v160, v160
    v_rcp_f32 v161, v161
    v_rcp_f32 v162, v162
    v_rcp_f32 v163, v163
    v_rcp_f32 v164, v164
    v_rcp_f32 v165, v165
    v_rcp_f32 v166, v166
    v_rcp_f32 v167, v167
    v_pk_mul_f32 v[160:161], v[160:161], v[68:69] op_sel:[0,0] op_sel_hi:[1,1]
    v_pk_mul_f32 v[162:163], v[162:163], v[70:71] op_sel:[0,0] op_sel_hi:[1,1]
    v_pk_mul_f32 v[164:165], v[164:165], v[72:73] op_sel:[0,0] op_sel_hi:[1,1]
    v_pk_mul_f32 v[166:167], v[166:167], v[74:75] op_sel:[0,0] op_sel_hi:[1,1]
    v_cvt_pk_bf16_f32 v68, v160, v161
    v_cvt_pk_bf16_f32 v69, v162, v163
    v_cvt_pk_bf16_f32 v72, v164, v165
    v_cvt_pk_bf16_f32 v73, v166, v167
    v_pk_fma_f32 v[160:161], v[226:227], v[140:141], v[200:201] op_sel:[0,0,0] op_sel_hi:[0,1,1]
    v_pk_fma_f32 v[162:163], v[226:227], v[142:143], v[202:203] op_sel:[0,0,0] op_sel_hi:[0,1,1]
    v_pk_fma_f32 v[164:165], v[230:231], v[140:141], v[200:201] op_sel:[0,0,0] op_sel_hi:[0,1,1]
    v_pk_fma_f32 v[166:167], v[230:231], v[142:143], v[202:203] op_sel:[0,0,0] op_sel_hi:[0,1,1]
    v_pk_fma_f32 v[84:85], v[224:225], v[84:85], v[160:161] op_sel:[0,0,0] op_sel_hi:[0,1,1]
    v_pk_fma_f32 v[86:87], v[224:225], v[86:87], v[162:163] op_sel:[0,0,0] op_sel_hi:[0,1,1]
    v_pk_fma_f32 v[88:89], v[228:229], v[88:89], v[164:165] op_sel:[0,0,0] op_sel_hi:[0,1,1]
    v_pk_fma_f32 v[90:91], v[228:229], v[90:91], v[166:167] op_sel:[0,0,0] op_sel_hi:[0,1,1]
    v_pk_mul_f32 v[160:161], v[84:85], v[84:85] op_sel:[0,0] op_sel_hi:[1,1]
    v_pk_mul_f32 v[162:163], v[86:87], v[86:87] op_sel:[0,0] op_sel_hi:[1,1]
    v_pk_mul_f32 v[164:165], v[88:89], v[88:89] op_sel:[0,0] op_sel_hi:[1,1]
    v_pk_mul_f32 v[166:167], v[90:91], v[90:91] op_sel:[0,0] op_sel_hi:[1,1]
    v_pk_fma_f32 v[160:161], v[160:161], s[100:101], v[250:251] op_sel:[0,0,0] op_sel_hi:[1,0,0]
    v_pk_fma_f32 v[162:163], v[162:163], s[100:101], v[250:251] op_sel:[0,0,0] op_sel_hi:[1,0,0]
    v_pk_fma_f32 v[164:165], v[164:165], s[100:101], v[250:251] op_sel:[0,0,0] op_sel_hi:[1,0,0]
    v_pk_fma_f32 v[166:167], v[166:167], s[100:101], v[250:251] op_sel:[0,0,0] op_sel_hi:[1,0,0]
    v_pk_mul_f32 v[160:161], v[160:161], v[84:85] op_sel:[0,0] op_sel_hi:[1,1]
    v_pk_mul_f32 v[162:163], v[162:163], v[86:87] op_sel:[0,0] op_sel_hi:[1,1]
    v_pk_mul_f32 v[164:165], v[164:165], v[88:89] op_sel:[0,0] op_sel_hi:[1,1]
    v_pk_mul_f32 v[166:167], v[166:167], v[90:91] op_sel:[0,0] op_sel_hi:[1,1]
    v_exp_f32 v160, v160
    v_exp_f32 v161, v161
    v_exp_f32 v162, v162
    v_exp_f32 v163, v163
    v_exp_f32 v164, v164
    v_exp_f32 v165, v165
    v_exp_f32 v166, v166
    v_exp_f32 v167, v167
    v_pk_add_f32 v[160:161], v[160:161], 1.0 op_sel:[0,0] op_sel_hi:[1,0]
    v_pk_add_f32 v[162:163], v[162:163], 1.0 op_sel:[0,0] op_sel_hi:[1,0]
    v_pk_add_f32 v[164:165], v[164:165], 1.0 op_sel:[0,0] op_sel_hi:[1,0]
    v_pk_add_f32 v[166:167], v[166:167], 1.0 op_sel:[0,0] op_sel_hi:[1,0]
    v_rcp_f32 v160, v160
    v_rcp_f32 v161, v161
    v_rcp_f32 v162, v162
    v_rcp_f32 v163, v163
    v_rcp_f32 v164, v164
    v_rcp_f32 v165, v165
    v_rcp_f32 v166, v166
    v_rcp_f32 v167, v167
    v_pk_mul_f32 v[160:161], v[160:161], v[84:85] op_sel:[0,0] op_sel_hi:[1,1]
    v_pk_mul_f32 v[162:163], v[162:163], v[86:87] op_sel:[0,0] op_sel_hi:[1,1]
    v_pk_mul_f32 v[164:165], v[164:165], v[88:89] op_sel:[0,0] op_sel_hi:[1,1]
    v_pk_mul_f32 v[166:167], v[166:167], v[90:91] op_sel:[0,0] op_sel_hi:[1,1]
    v_cvt_pk_bf16_f32 v70, v160, v161
    v_cvt_pk_bf16_f32 v71, v162, v163
    v_cvt_pk_bf16_f32 v74, v164, v165
    v_cvt_pk_bf16_f32 v75, v166, v167
    s_add_u32 s70, s77, 49152
    buffer_store_dwordx4 v[68:71], v2, s[44:47], s77 offen offset:0 sc1
    buffer_store_dwordx4 v[72:75], v2, s[44:47], s70 offen offset:0 sc1
    ds_read_b128 v[144:147], v5 offset:320
    ds_read_b64 v[156:157], v7 offset:64
    v_mfma_f32_16x16x32_bf16 v[92:95], v[204:207], v[168:171], v[92:95]
    ds_read_b128 v[148:151], v5 offset:384
    v_mfma_f32_16x16x32_bf16 v[96:99], v[204:207], v[172:175], v[96:99]
    ds_read_b64 v[158:159], v7 offset:96
    v_mfma_f32_16x16x32_bf16 v[100:103], v[204:207], v[176:179], v[100:103]
    ds_read_b32 v232, v251 offset:0
    v_mfma_f32_16x16x32_bf16 v[104:107], v[204:207], v[180:183], v[104:107]
    ds_read_b32 v234, v251 offset:512
    v_mfma_f32_16x16x32_bf16 v[108:111], v[208:211], v[168:171], v[108:111]
    ds_read_b32 v236, v251 offset:64
    v_mfma_f32_16x16x32_bf16 v[112:115], v[208:211], v[172:175], v[112:115]
    v_mfma_f32_16x16x32_bf16 v[116:119], v[208:211], v[176:179], v[116:119]
    ds_read_b32 v238, v251 offset:576
    v_mfma_f32_16x16x32_bf16 v[120:123], v[208:211], v[180:183], v[120:123]
    ds_read_b32 v240, v6 offset:0
    v_mfma_f32_16x16x32_bf16 v[12:15], v[184:187], v[168:171], v[12:15]
    ds_read_b32 v242, v6 offset:512
    v_mfma_f32_16x16x32_bf16 v[16:19], v[184:187], v[172:175], v[16:19]
    ds_read_b32 v244, v6 offset:64
    v_mfma_f32_16x16x32_bf16 v[20:23], v[184:187], v[176:179], v[20:23]
    v_mfma_f32_16x16x32_bf16 v[24:27], v[184:187], v[180:183], v[24:27]
    ds_read_b32 v246, v6 offset:576
    v_mfma_f32_16x16x32_bf16 v[28:31], v[188:191], v[168:171], v[28:31]
    ds_read_b128 v[124:127], v5 offset:0
    v_mfma_f32_16x16x32_bf16 v[32:35], v[188:191], v[172:175], v[32:35]
    ds_read_b128 v[128:131], v5 offset:64
    v_mfma_f32_16x16x32_bf16 v[36:39], v[188:191], v[176:179], v[36:39]
    ds_read_b128 v[132:135], v5 offset:128
    v_mfma_f32_16x16x32_bf16 v[40:43], v[188:191], v[180:183], v[40:43]
    v_mfma_f32_16x16x32_bf16 v[44:47], v[192:195], v[168:171], v[44:47]
    v_mfma_f32_16x16x32_bf16 v[48:51], v[192:195], v[172:175], v[48:51]
    v_mfma_f32_16x16x32_bf16 v[52:55], v[192:195], v[176:179], v[52:55]
    v_mfma_f32_16x16x32_bf16 v[56:59], v[192:195], v[180:183], v[56:59]
    s_waitcnt vmcnt(0) lgkmcnt(0)
    v_mov_b32 v4, 89092
    v_mov_b32 v5, 1
    s_mov_b64 exec, 1
    ds_add_u32 v4, v5
    s_mov_b64 exec, -1
    v_lshlrev_b32 v196, 16, v156
    v_and_b32 v197, s101, v156
    v_lshlrev_b32 v198, 16, v157
    v_and_b32 v199, s101, v157
    v_pk_fma_f32 v[160:161], v[218:219], v[144:145], v[196:197] op_sel:[0,0,0] op_sel_hi:[0,1,1]
    v_pk_fma_f32 v[162:163], v[218:219], v[146:147], v[198:199] op_sel:[0,0,0] op_sel_hi:[0,1,1]
    v_pk_fma_f32 v[164:165], v[222:223], v[144:145], v[196:197] op_sel:[0,0,0] op_sel_hi:[0,1,1]
    v_pk_fma_f32 v[166:167], v[222:223], v[146:147], v[198:199] op_sel:[0,0,0] op_sel_hi:[0,1,1]
    v_pk_fma_f32 v[92:93], v[216:217], v[92:93], v[160:161] op_sel:[0,0,0] op_sel_hi:[0,1,1]
    v_pk_fma_f32 v[94:95], v[216:217], v[94:95], v[162:163] op_sel:[0,0,0] op_sel_hi:[0,1,1]
    v_pk_fma_f32 v[96:97], v[220:221], v[96:97], v[164:165] op_sel:[0,0,0] op_sel_hi:[0,1,1]
    v_pk_fma_f32 v[98:99], v[220:221], v[98:99], v[166:167] op_sel:[0,0,0] op_sel_hi:[0,1,1]
    v_pk_mul_f32 v[160:161], v[92:93], v[92:93] op_sel:[0,0] op_sel_hi:[1,1]
    v_pk_mul_f32 v[162:163], v[94:95], v[94:95] op_sel:[0,0] op_sel_hi:[1,1]
    v_pk_mul_f32 v[164:165], v[96:97], v[96:97] op_sel:[0,0] op_sel_hi:[1,1]
    v_pk_mul_f32 v[166:167], v[98:99], v[98:99] op_sel:[0,0] op_sel_hi:[1,1]
    v_pk_fma_f32 v[160:161], v[160:161], s[100:101], v[250:251] op_sel:[0,0,0] op_sel_hi:[1,0,0]
    v_pk_fma_f32 v[162:163], v[162:163], s[100:101], v[250:251] op_sel:[0,0,0] op_sel_hi:[1,0,0]
    v_pk_fma_f32 v[164:165], v[164:165], s[100:101], v[250:251] op_sel:[0,0,0] op_sel_hi:[1,0,0]
    v_pk_fma_f32 v[166:167], v[166:167], s[100:101], v[250:251] op_sel:[0,0,0] op_sel_hi:[1,0,0]
    v_pk_mul_f32 v[160:161], v[160:161], v[92:93] op_sel:[0,0] op_sel_hi:[1,1]
    v_pk_mul_f32 v[162:163], v[162:163], v[94:95] op_sel:[0,0] op_sel_hi:[1,1]
    v_pk_mul_f32 v[164:165], v[164:165], v[96:97] op_sel:[0,0] op_sel_hi:[1,1]
    v_pk_mul_f32 v[166:167], v[166:167], v[98:99] op_sel:[0,0] op_sel_hi:[1,1]
    v_exp_f32 v160, v160
    v_exp_f32 v161, v161
    v_exp_f32 v162, v162
    v_exp_f32 v163, v163
    v_exp_f32 v164, v164
    v_exp_f32 v165, v165
    v_exp_f32 v166, v166
    v_exp_f32 v167, v167
    v_pk_add_f32 v[160:161], v[160:161], 1.0 op_sel:[0,0] op_sel_hi:[1,0]
    v_pk_add_f32 v[162:163], v[162:163], 1.0 op_sel:[0,0] op_sel_hi:[1,0]
    v_pk_add_f32 v[164:165], v[164:165], 1.0 op_sel:[0,0] op_sel_hi:[1,0]
    v_pk_add_f32 v[166:167], v[166:167], 1.0 op_sel:[0,0] op_sel_hi:[1,0]
    v_rcp_f32 v160, v160
    v_rcp_f32 v161, v161
    v_rcp_f32 v162, v162
    v_rcp_f32 v163, v163
    v_rcp_f32 v164, v164
    v_rcp_f32 v165, v165
    v_rcp_f32 v166, v166
    v_rcp_f32 v167, v167
    v_pk_mul_f32 v[160:161], v[160:161], v[92:93] op_sel:[0,0] op_sel_hi:[1,1]
    v_pk_mul_f32 v[162:163], v[162:163], v[94:95] op_sel:[0,0] op_sel_hi:[1,1]
    v_pk_mul_f32 v[164:165], v[164:165], v[96:97] op_sel:[0,0] op_sel_hi:[1,1]
    v_pk_mul_f32 v[166:167], v[166:167], v[98:99] op_sel:[0,0] op_sel_hi:[1,1]
    v_cvt_pk_bf16_f32 v92, v160, v161
    v_cvt_pk_bf16_f32 v93, v162, v163
    v_cvt_pk_bf16_f32 v96, v164, v165
    v_cvt_pk_bf16_f32 v97, v166, v167
    v_lshlrev_b32 v200, 16, v158
    v_and_b32 v201, s101, v158
    v_lshlrev_b32 v202, 16, v159
    v_and_b32 v203, s101, v159
    v_pk_fma_f32 v[160:161], v[218:219], v[148:149], v[200:201] op_sel:[0,0,0] op_sel_hi:[0,1,1]
    v_pk_fma_f32 v[162:163], v[218:219], v[150:151], v[202:203] op_sel:[0,0,0] op_sel_hi:[0,1,1]
    v_pk_fma_f32 v[164:165], v[222:223], v[148:149], v[200:201] op_sel:[0,0,0] op_sel_hi:[0,1,1]
    v_pk_fma_f32 v[166:167], v[222:223], v[150:151], v[202:203] op_sel:[0,0,0] op_sel_hi:[0,1,1]
    v_pk_fma_f32 v[108:109], v[216:217], v[108:109], v[160:161] op_sel:[0,0,0] op_sel_hi:[0,1,1]
    v_pk_fma_f32 v[110:111], v[216:217], v[110:111], v[162:163] op_sel:[0,0,0] op_sel_hi:[0,1,1]
    v_pk_fma_f32 v[112:113], v[220:221], v[112:113], v[164:165] op_sel:[0,0,0] op_sel_hi:[0,1,1]
    v_pk_fma_f32 v[114:115], v[220:221], v[114:115], v[166:167] op_sel:[0,0,0] op_sel_hi:[0,1,1]
    v_pk_mul_f32 v[160:161], v[108:109], v[108:109] op_sel:[0,0] op_sel_hi:[1,1]
    v_pk_mul_f32 v[162:163], v[110:111], v[110:111] op_sel:[0,0] op_sel_hi:[1,1]
    v_pk_mul_f32 v[164:165], v[112:113], v[112:113] op_sel:[0,0] op_sel_hi:[1,1]
    v_pk_mul_f32 v[166:167], v[114:115], v[114:115] op_sel:[0,0] op_sel_hi:[1,1]
    v_pk_fma_f32 v[160:161], v[160:161], s[100:101], v[250:251] op_sel:[0,0,0] op_sel_hi:[1,0,0]
    v_pk_fma_f32 v[162:163], v[162:163], s[100:101], v[250:251] op_sel:[0,0,0] op_sel_hi:[1,0,0]
    v_pk_fma_f32 v[164:165], v[164:165], s[100:101], v[250:251] op_sel:[0,0,0] op_sel_hi:[1,0,0]
    v_pk_fma_f32 v[166:167], v[166:167], s[100:101], v[250:251] op_sel:[0,0,0] op_sel_hi:[1,0,0]
    v_pk_mul_f32 v[160:161], v[160:161], v[108:109] op_sel:[0,0] op_sel_hi:[1,1]
    v_pk_mul_f32 v[162:163], v[162:163], v[110:111] op_sel:[0,0] op_sel_hi:[1,1]
    v_pk_mul_f32 v[164:165], v[164:165], v[112:113] op_sel:[0,0] op_sel_hi:[1,1]
    v_pk_mul_f32 v[166:167], v[166:167], v[114:115] op_sel:[0,0] op_sel_hi:[1,1]
    v_exp_f32 v160, v160
    v_exp_f32 v161, v161
    v_exp_f32 v162, v162
    v_exp_f32 v163, v163
    v_exp_f32 v164, v164
    v_exp_f32 v165, v165
    v_exp_f32 v166, v166
    v_exp_f32 v167, v167
    v_pk_add_f32 v[160:161], v[160:161], 1.0 op_sel:[0,0] op_sel_hi:[1,0]
    v_pk_add_f32 v[162:163], v[162:163], 1.0 op_sel:[0,0] op_sel_hi:[1,0]
    v_pk_add_f32 v[164:165], v[164:165], 1.0 op_sel:[0,0] op_sel_hi:[1,0]
    v_pk_add_f32 v[166:167], v[166:167], 1.0 op_sel:[0,0] op_sel_hi:[1,0]
    v_rcp_f32 v160, v160
    v_rcp_f32 v161, v161
    v_rcp_f32 v162, v162
    v_rcp_f32 v163, v163
    v_rcp_f32 v164, v164
    v_rcp_f32 v165, v165
    v_rcp_f32 v166, v166
    v_rcp_f32 v167, v167
    v_pk_mul_f32 v[160:161], v[160:161], v[108:109] op_sel:[0,0] op_sel_hi:[1,1]
    v_pk_mul_f32 v[162:163], v[162:163], v[110:111] op_sel:[0,0] op_sel_hi:[1,1]
    v_pk_mul_f32 v[164:165], v[164:165], v[112:113] op_sel:[0,0] op_sel_hi:[1,1]
    v_pk_mul_f32 v[166:167], v[166:167], v[114:115] op_sel:[0,0] op_sel_hi:[1,1]
    v_cvt_pk_bf16_f32 v94, v160, v161
    v_cvt_pk_bf16_f32 v95, v162, v163
    v_cvt_pk_bf16_f32 v98, v164, v165
    v_cvt_pk_bf16_f32 v99, v166, v167
    s_add_u32 s70, s76, 49152
    buffer_store_dwordx4 v[92:95], v2, s[44:47], s76 offen offset:2048 sc1
    buffer_store_dwordx4 v[96:99], v2, s[44:47], s70 offen offset:2048 sc1
    v_pk_fma_f32 v[160:161], v[226:227], v[144:145], v[196:197] op_sel:[0,0,0] op_sel_hi:[0,1,1]
    v_pk_fma_f32 v[162:163], v[226:227], v[146:147], v[198:199] op_sel:[0,0,0] op_sel_hi:[0,1,1]
    v_pk_fma_f32 v[164:165], v[230:231], v[144:145], v[196:197] op_sel:[0,0,0] op_sel_hi:[0,1,1]
    v_pk_fma_f32 v[166:167], v[230:231], v[146:147], v[198:199] op_sel:[0,0,0] op_sel_hi:[0,1,1]
    v_pk_fma_f32 v[100:101], v[224:225], v[100:101], v[160:161] op_sel:[0,0,0] op_sel_hi:[0,1,1]
    v_pk_fma_f32 v[102:103], v[224:225], v[102:103], v[162:163] op_sel:[0,0,0] op_sel_hi:[0,1,1]
    v_pk_fma_f32 v[104:105], v[228:229], v[104:105], v[164:165] op_sel:[0,0,0] op_sel_hi:[0,1,1]
    v_pk_fma_f32 v[106:107], v[228:229], v[106:107], v[166:167] op_sel:[0,0,0] op_sel_hi:[0,1,1]
    v_pk_mul_f32 v[160:161], v[100:101], v[100:101] op_sel:[0,0] op_sel_hi:[1,1]
    v_pk_mul_f32 v[162:163], v[102:103], v[102:103] op_sel:[0,0] op_sel_hi:[1,1]
    v_pk_mul_f32 v[164:165], v[104:105], v[104:105] op_sel:[0,0] op_sel_hi:[1,1]
    v_pk_mul_f32 v[166:167], v[106:107], v[106:107] op_sel:[0,0] op_sel_hi:[1,1]
    v_pk_fma_f32 v[160:161], v[160:161], s[100:101], v[250:251] op_sel:[0,0,0] op_sel_hi:[1,0,0]
    v_pk_fma_f32 v[162:163], v[162:163], s[100:101], v[250:251] op_sel:[0,0,0] op_sel_hi:[1,0,0]
    v_pk_fma_f32 v[164:165], v[164:165], s[100:101], v[250:251] op_sel:[0,0,0] op_sel_hi:[1,0,0]
    v_pk_fma_f32 v[166:167], v[166:167], s[100:101], v[250:251] op_sel:[0,0,0] op_sel_hi:[1,0,0]
    v_pk_mul_f32 v[160:161], v[160:161], v[100:101] op_sel:[0,0] op_sel_hi:[1,1]
    v_pk_mul_f32 v[162:163], v[162:163], v[102:103] op_sel:[0,0] op_sel_hi:[1,1]
    v_pk_mul_f32 v[164:165], v[164:165], v[104:105] op_sel:[0,0] op_sel_hi:[1,1]
    v_pk_mul_f32 v[166:167], v[166:167], v[106:107] op_sel:[0,0] op_sel_hi:[1,1]
    v_exp_f32 v160, v160
    v_exp_f32 v161, v161
    v_exp_f32 v162, v162
    v_exp_f32 v163, v163
    v_exp_f32 v164, v164
    v_exp_f32 v165, v165
    v_exp_f32 v166, v166
    v_exp_f32 v167, v167
    v_pk_add_f32 v[160:161], v[160:161], 1.0 op_sel:[0,0] op_sel_hi:[1,0]
    v_pk_add_f32 v[162:163], v[162:163], 1.0 op_sel:[0,0] op_sel_hi:[1,0]
    v_pk_add_f32 v[164:165], v[164:165], 1.0 op_sel:[0,0] op_sel_hi:[1,0]
    v_pk_add_f32 v[166:167], v[166:167], 1.0 op_sel:[0,0] op_sel_hi:[1,0]
    v_rcp_f32 v160, v160
    v_rcp_f32 v161, v161
    v_rcp_f32 v162, v162
    v_rcp_f32 v163, v163
    v_rcp_f32 v164, v164
    v_rcp_f32 v165, v165
    v_rcp_f32 v166, v166
    v_rcp_f32 v167, v167
    v_pk_mul_f32 v[160:161], v[160:161], v[100:101] op_sel:[0,0] op_sel_hi:[1,1]
    v_pk_mul_f32 v[162:163], v[162:163], v[102:103] op_sel:[0,0] op_sel_hi:[1,1]
    v_pk_mul_f32 v[164:165], v[164:165], v[104:105] op_sel:[0,0] op_sel_hi:[1,1]
    v_pk_mul_f32 v[166:167], v[166:167], v[106:107] op_sel:[0,0] op_sel_hi:[1,1]
    v_cvt_pk_bf16_f32 v100, v160, v161
    v_cvt_pk_bf16_f32 v101, v162, v163
    v_cvt_pk_bf16_f32 v104, v164, v165
    v_cvt_pk_bf16_f32 v105, v166, v167
    v_pk_fma_f32 v[160:161], v[226:227], v[148:149], v[200:201] op_sel:[0,0,0] op_sel_hi:[0,1,1]
    v_pk_fma_f32 v[162:163], v[226:227], v[150:151], v[202:203] op_sel:[0,0,0] op_sel_hi:[0,1,1]
    v_pk_fma_f32 v[164:165], v[230:231], v[148:149], v[200:201] op_sel:[0,0,0] op_sel_hi:[0,1,1]
    v_pk_fma_f32 v[166:167], v[230:231], v[150:151], v[202:203] op_sel:[0,0,0] op_sel_hi:[0,1,1]
    v_pk_fma_f32 v[116:117], v[224:225], v[116:117], v[160:161] op_sel:[0,0,0] op_sel_hi:[0,1,1]
    v_pk_fma_f32 v[118:119], v[224:225], v[118:119], v[162:163] op_sel:[0,0,0] op_sel_hi:[0,1,1]
    v_pk_fma_f32 v[120:121], v[228:229], v[120:121], v[164:165] op_sel:[0,0,0] op_sel_hi:[0,1,1]
    v_pk_fma_f32 v[122:123], v[228:229], v[122:123], v[166:167] op_sel:[0,0,0] op_sel_hi:[0,1,1]
    v_pk_mul_f32 v[160:161], v[116:117], v[116:117] op_sel:[0,0] op_sel_hi:[1,1]
    v_pk_mul_f32 v[162:163], v[118:119], v[118:119] op_sel:[0,0] op_sel_hi:[1,1]
    v_pk_mul_f32 v[164:165], v[120:121], v[120:121] op_sel:[0,0] op_sel_hi:[1,1]
    v_pk_mul_f32 v[166:167], v[122:123], v[122:123] op_sel:[0,0] op_sel_hi:[1,1]
    v_pk_fma_f32 v[160:161], v[160:161], s[100:101], v[250:251] op_sel:[0,0,0] op_sel_hi:[1,0,0]
    v_pk_fma_f32 v[162:163], v[162:163], s[100:101], v[250:251] op_sel:[0,0,0] op_sel_hi:[1,0,0]
    v_pk_fma_f32 v[164:165], v[164:165], s[100:101], v[250:251] op_sel:[0,0,0] op_sel_hi:[1,0,0]
    v_pk_fma_f32 v[166:167], v[166:167], s[100:101], v[250:251] op_sel:[0,0,0] op_sel_hi:[1,0,0]
    v_pk_mul_f32 v[160:161], v[160:161], v[116:117] op_sel:[0,0] op_sel_hi:[1,1]
    v_pk_mul_f32 v[162:163], v[162:163], v[118:119] op_sel:[0,0] op_sel_hi:[1,1]
    v_pk_mul_f32 v[164:165], v[164:165], v[120:121] op_sel:[0,0] op_sel_hi:[1,1]
    v_pk_mul_f32 v[166:167], v[166:167], v[122:123] op_sel:[0,0] op_sel_hi:[1,1]
    v_exp_f32 v160, v160
    v_exp_f32 v161, v161
    v_exp_f32 v162, v162
    v_exp_f32 v163, v163
    v_exp_f32 v164, v164
    v_exp_f32 v165, v165
    v_exp_f32 v166, v166
    v_exp_f32 v167, v167
    v_pk_add_f32 v[160:161], v[160:161], 1.0 op_sel:[0,0] op_sel_hi:[1,0]
    v_pk_add_f32 v[162:163], v[162:163], 1.0 op_sel:[0,0] op_sel_hi:[1,0]
    v_pk_add_f32 v[164:165], v[164:165], 1.0 op_sel:[0,0] op_sel_hi:[1,0]
    v_pk_add_f32 v[166:167], v[166:167], 1.0 op_sel:[0,0] op_sel_hi:[1,0]
    v_rcp_f32 v160, v160
    v_rcp_f32 v161, v161
    v_rcp_f32 v162, v162
    v_rcp_f32 v163, v163
    v_rcp_f32 v164, v164
    v_rcp_f32 v165, v165
    v_rcp_f32 v166, v166
    v_rcp_f32 v167, v167
    v_pk_mul_f32 v[160:161], v[160:161], v[116:117] op_sel:[0,0] op_sel_hi:[1,1]
    v_pk_mul_f32 v[162:163], v[162:163], v[118:119] op_sel:[0,0] op_sel_hi:[1,1]
    v_pk_mul_f32 v[164:165], v[164:165], v[120:121] op_sel:[0,0] op_sel_hi:[1,1]
    v_pk_mul_f32 v[166:167], v[166:167], v[122:123] op_sel:[0,0] op_sel_hi:[1,1]
    v_cvt_pk_bf16_f32 v102, v160, v161
    v_cvt_pk_bf16_f32 v103, v162, v163
    v_cvt_pk_bf16_f32 v106, v164, v165
    v_cvt_pk_bf16_f32 v107, v166, v167
    s_add_u32 s70, s77, 49152
    buffer_store_dwordx4 v[100:103], v2, s[44:47], s77 offen offset:2048 sc1
    buffer_store_dwordx4 v[104:107], v2, s[44:47], s70 offen offset:2048 sc1
    v_mov_b32 v160, 0x358637bd
    s_mov_b32 s100, 0x3fb8aa3b
    v_pk_fma_f32 v[136:137], v[234:235], v[124:125], v[160:161] op_sel:[0,0,0] op_sel_hi:[0,1,0]
    v_pk_fma_f32 v[138:139], v[234:235], v[126:127], v[160:161] op_sel:[0,0,0] op_sel_hi:[0,1,0]
    v_pk_fma_f32 v[140:141], v[238:239], v[124:125], v[160:161] op_sel:[0,0,0] op_sel_hi:[0,1,0]
    v_pk_fma_f32 v[142:143], v[238:239], v[126:127], v[160:161] op_sel:[0,0,0] op_sel_hi:[0,1,0]
    v_pk_fma_f32 v[12:13], v[232:233], v[12:13], v[136:137] op_sel:[0,0,0] op_sel_hi:[0,1,1]
    v_pk_fma_f32 v[14:15], v[232:233], v[14:15], v[138:139] op_sel:[0,0,0] op_sel_hi:[0,1,1]
    v_pk_fma_f32 v[16:17], v[236:237], v[16:17], v[140:141] op_sel:[0,0,0] op_sel_hi:[0,1,1]
    v_pk_fma_f32 v[18:19], v[236:237], v[18:19], v[142:143] op_sel:[0,0,0] op_sel_hi:[0,1,1]
    v_pk_mul_f32 v[136:137], v[12:13], s[100:101] op_sel:[0,0] op_sel_hi:[1,0]
    v_pk_mul_f32 v[138:139], v[14:15], s[100:101] op_sel:[0,0] op_sel_hi:[1,0]
    v_pk_mul_f32 v[140:141], v[16:17], s[100:101] op_sel:[0,0] op_sel_hi:[1,0]
    v_pk_mul_f32 v[142:143], v[18:19], s[100:101] op_sel:[0,0] op_sel_hi:[1,0]
    v_exp_f32 v136, v136 clamp
    v_exp_f32 v137, v137 clamp
    v_exp_f32 v138, v138 clamp
    v_exp_f32 v139, v139 clamp
    v_exp_f32 v140, v140 clamp
    v_exp_f32 v141, v141 clamp
    v_exp_f32 v142, v142 clamp
    v_exp_f32 v143, v143 clamp
    v_max_f32 v144, v160, v12
    v_max_f32 v145, v160, v13
    v_max_f32 v146, v160, v14
    v_max_f32 v147, v160, v15
    v_max_f32 v148, v160, v16
    v_max_f32 v149, v160, v17
    v_max_f32 v150, v160, v18
    v_max_f32 v151, v160, v19
    v_pk_add_f32 v[136:137], v[136:137], v[144:145] op_sel:[0,0] op_sel_hi:[1,1]
    v_pk_add_f32 v[138:139], v[138:139], v[146:147] op_sel:[0,0] op_sel_hi:[1,1]
    v_pk_add_f32 v[140:141], v[140:141], v[148:149] op_sel:[0,0] op_sel_hi:[1,1]
    v_pk_add_f32 v[142:143], v[142:143], v[150:151] op_sel:[0,0] op_sel_hi:[1,1]
    v_cvt_pk_bf16_f32 v208, v136, v137
    v_cvt_pk_bf16_f32 v209, v138, v139
    v_cvt_pk_bf16_f32 v212, v140, v141
    v_cvt_pk_bf16_f32 v213, v142, v143
    v_pk_fma_f32 v[136:137], v[234:235], v[128:129], v[160:161] op_sel:[0,0,0] op_sel_hi:[0,1,0]
    v_pk_fma_f32 v[138:139], v[234:235], v[130:131], v[160:161] op_sel:[0,0,0] op_sel_hi:[0,1,0]
    v_pk_fma_f32 v[140:141], v[238:239], v[128:129], v[160:161] op_sel:[0,0,0] op_sel_hi:[0,1,0]
    v_pk_fma_f32 v[142:143], v[238:239], v[130:131], v[160:161] op_sel:[0,0,0] op_sel_hi:[0,1,0]
    v_pk_fma_f32 v[28:29], v[232:233], v[28:29], v[136:137] op_sel:[0,0,0] op_sel_hi:[0,1,1]
    v_pk_fma_f32 v[30:31], v[232:233], v[30:31], v[138:139] op_sel:[0,0,0] op_sel_hi:[0,1,1]
    v_pk_fma_f32 v[32:33], v[236:237], v[32:33], v[140:141] op_sel:[0,0,0] op_sel_hi:[0,1,1]
    v_pk_fma_f32 v[34:35], v[236:237], v[34:35], v[142:143] op_sel:[0,0,0] op_sel_hi:[0,1,1]
    v_pk_mul_f32 v[136:137], v[28:29], s[100:101] op_sel:[0,0] op_sel_hi:[1,0]
    v_pk_mul_f32 v[138:139], v[30:31], s[100:101] op_sel:[0,0] op_sel_hi:[1,0]
    v_pk_mul_f32 v[140:141], v[32:33], s[100:101] op_sel:[0,0] op_sel_hi:[1,0]
    v_pk_mul_f32 v[142:143], v[34:35], s[100:101] op_sel:[0,0] op_sel_hi:[1,0]
    v_exp_f32 v136, v136 clamp
    v_exp_f32 v137, v137 clamp
    v_exp_f32 v138, v138 clamp
    v_exp_f32 v139, v139 clamp
    v_exp_f32 v140, v140 clamp
    v_exp_f32 v141, v141 clamp
    v_exp_f32 v142, v142 clamp
    v_exp_f32 v143, v143 clamp
    v_max_f32 v144, v160, v28
    v_max_f32 v145, v160, v29
    v_max_f32 v146, v160, v30
    v_max_f32 v147, v160, v31
    v_max_f32 v148, v160, v32
    v_max_f32 v149, v160, v33
    v_max_f32 v150, v160, v34
    v_max_f32 v151, v160, v35
    v_pk_add_f32 v[136:137], v[136:137], v[144:145] op_sel:[0,0] op_sel_hi:[1,1]
    v_pk_add_f32 v[138:139], v[138:139], v[146:147] op_sel:[0,0] op_sel_hi:[1,1]
    v_pk_add_f32 v[140:141], v[140:141], v[148:149] op_sel:[0,0] op_sel_hi:[1,1]
    v_pk_add_f32 v[142:143], v[142:143], v[150:151] op_sel:[0,0] op_sel_hi:[1,1]
    v_cvt_pk_bf16_f32 v210, v136, v137
    v_cvt_pk_bf16_f32 v211, v138, v139
    v_cvt_pk_bf16_f32 v214, v140, v141
    v_cvt_pk_bf16_f32 v215, v142, v143
    v_pk_fma_f32 v[136:137], v[234:235], v[132:133], v[160:161] op_sel:[0,0,0] op_sel_hi:[0,1,0]
    v_pk_fma_f32 v[138:139], v[234:235], v[134:135], v[160:161] op_sel:[0,0,0] op_sel_hi:[0,1,0]
    v_pk_fma_f32 v[140:141], v[238:239], v[132:133], v[160:161] op_sel:[0,0,0] op_sel_hi:[0,1,0]
    v_pk_fma_f32 v[142:143], v[238:239], v[134:135], v[160:161] op_sel:[0,0,0] op_sel_hi:[0,1,0]
    v_pk_fma_f32 v[44:45], v[232:233], v[44:45], v[136:137] op_sel:[0,0,0] op_sel_hi:[0,1,1]
    v_pk_fma_f32 v[46:47], v[232:233], v[46:47], v[138:139] op_sel:[0,0,0] op_sel_hi:[0,1,1]
    v_pk_fma_f32 v[48:49], v[236:237], v[48:49], v[140:141] op_sel:[0,0,0] op_sel_hi:[0,1,1]
    v_pk_fma_f32 v[50:51], v[236:237], v[50:51], v[142:143] op_sel:[0,0,0] op_sel_hi:[0,1,1]
    v_pk_mul_f32 v[136:137], v[44:45], s[100:101] op_sel:[0,0] op_sel_hi:[1,0]
    v_pk_mul_f32 v[138:139], v[46:47], s[100:101] op_sel:[0,0] op_sel_hi:[1,0]
    v_pk_mul_f32 v[140:141], v[48:49], s[100:101] op_sel:[0,0] op_sel_hi:[1,0]
    v_pk_mul_f32 v[142:143], v[50:51], s[100:101] op_sel:[0,0] op_sel_hi:[1,0]
    v_exp_f32 v136, v136 clamp
    v_exp_f32 v137, v137 clamp
    v_exp_f32 v138, v138 clamp
    v_exp_f32 v139, v139 clamp
    v_exp_f32 v140, v140 clamp
    v_exp_f32 v141, v141 clamp
    v_exp_f32 v142, v142 clamp
    v_exp_f32 v143, v143 clamp
    v_max_f32 v144, v160, v44
    v_max_f32 v145, v160, v45
    v_max_f32 v146, v160, v46
    v_max_f32 v147, v160, v47
    v_max_f32 v148, v160, v48
    v_max_f32 v149, v160, v49
    v_max_f32 v150, v160, v50
    v_max_f32 v151, v160, v51
    v_pk_add_f32 v[136:137], v[136:137], v[144:145] op_sel:[0,0] op_sel_hi:[1,1]
    v_pk_add_f32 v[138:139], v[138:139], v[146:147] op_sel:[0,0] op_sel_hi:[1,1]
    v_pk_add_f32 v[140:141], v[140:141], v[148:149] op_sel:[0,0] op_sel_hi:[1,1]
    v_pk_add_f32 v[142:143], v[142:143], v[150:151] op_sel:[0,0] op_sel_hi:[1,1]
    v_cvt_pk_bf16_f32 v224, v136, v137
    v_cvt_pk_bf16_f32 v225, v138, v139
    v_cvt_pk_bf16_f32 v226, v140, v141
    v_cvt_pk_bf16_f32 v227, v142, v143
    v_pk_fma_f32 v[136:137], v[242:243], v[124:125], v[160:161] op_sel:[0,0,0] op_sel_hi:[0,1,0]
    v_pk_fma_f32 v[138:139], v[242:243], v[126:127], v[160:161] op_sel:[0,0,0] op_sel_hi:[0,1,0]
    v_pk_fma_f32 v[140:141], v[246:247], v[124:125], v[160:161] op_sel:[0,0,0] op_sel_hi:[0,1,0]
    v_pk_fma_f32 v[142:143], v[246:247], v[126:127], v[160:161] op_sel:[0,0,0] op_sel_hi:[0,1,0]
    v_pk_fma_f32 v[20:21], v[240:241], v[20:21], v[136:137] op_sel:[0,0,0] op_sel_hi:[0,1,1]
    v_pk_fma_f32 v[22:23], v[240:241], v[22:23], v[138:139] op_sel:[0,0,0] op_sel_hi:[0,1,1]
    v_pk_fma_f32 v[24:25], v[244:245], v[24:25], v[140:141] op_sel:[0,0,0] op_sel_hi:[0,1,1]
    v_pk_fma_f32 v[26:27], v[244:245], v[26:27], v[142:143] op_sel:[0,0,0] op_sel_hi:[0,1,1]
    v_pk_mul_f32 v[136:137], v[20:21], s[100:101] op_sel:[0,0] op_sel_hi:[1,0]
    v_pk_mul_f32 v[138:139], v[22:23], s[100:101] op_sel:[0,0] op_sel_hi:[1,0]
    v_pk_mul_f32 v[140:141], v[24:25], s[100:101] op_sel:[0,0] op_sel_hi:[1,0]
    v_pk_mul_f32 v[142:143], v[26:27], s[100:101] op_sel:[0,0] op_sel_hi:[1,0]
    v_exp_f32 v136, v136 clamp
    v_exp_f32 v137, v137 clamp
    v_exp_f32 v138, v138 clamp
    v_exp_f32 v139, v139 clamp
    v_exp_f32 v140, v140 clamp
    v_exp_f32 v141, v141 clamp
    v_exp_f32 v142, v142 clamp
    v_exp_f32 v143, v143 clamp
    v_max_f32 v144, v160, v20
    v_max_f32 v145, v160, v21
    v_max_f32 v146, v160, v22
    v_max_f32 v147, v160, v23
    v_max_f32 v148, v160, v24
    v_max_f32 v149, v160, v25
    v_max_f32 v150, v160, v26
    v_max_f32 v151, v160, v27
    v_pk_add_f32 v[136:137], v[136:137], v[144:145] op_sel:[0,0] op_sel_hi:[1,1]
    v_pk_add_f32 v[138:139], v[138:139], v[146:147] op_sel:[0,0] op_sel_hi:[1,1]
    v_pk_add_f32 v[140:141], v[140:141], v[148:149] op_sel:[0,0] op_sel_hi:[1,1]
    v_pk_add_f32 v[142:143], v[142:143], v[150:151] op_sel:[0,0] op_sel_hi:[1,1]
    v_cvt_pk_bf16_f32 v216, v136, v137
    v_cvt_pk_bf16_f32 v217, v138, v139
    v_cvt_pk_bf16_f32 v220, v140, v141
    v_cvt_pk_bf16_f32 v221, v142, v143
    v_pk_fma_f32 v[136:137], v[242:243], v[128:129], v[160:161] op_sel:[0,0,0] op_sel_hi:[0,1,0]
    v_pk_fma_f32 v[138:139], v[242:243], v[130:131], v[160:161] op_sel:[0,0,0] op_sel_hi:[0,1,0]
    v_pk_fma_f32 v[140:141], v[246:247], v[128:129], v[160:161] op_sel:[0,0,0] op_sel_hi:[0,1,0]
    v_pk_fma_f32 v[142:143], v[246:247], v[130:131], v[160:161] op_sel:[0,0,0] op_sel_hi:[0,1,0]
    v_pk_fma_f32 v[36:37], v[240:241], v[36:37], v[136:137] op_sel:[0,0,0] op_sel_hi:[0,1,1]
    v_pk_fma_f32 v[38:39], v[240:241], v[38:39], v[138:139] op_sel:[0,0,0] op_sel_hi:[0,1,1]
    v_pk_fma_f32 v[40:41], v[244:245], v[40:41], v[140:141] op_sel:[0,0,0] op_sel_hi:[0,1,1]
    v_pk_fma_f32 v[42:43], v[244:245], v[42:43], v[142:143] op_sel:[0,0,0] op_sel_hi:[0,1,1]
    v_pk_mul_f32 v[136:137], v[36:37], s[100:101] op_sel:[0,0] op_sel_hi:[1,0]
    v_pk_mul_f32 v[138:139], v[38:39], s[100:101] op_sel:[0,0] op_sel_hi:[1,0]
    v_pk_mul_f32 v[140:141], v[40:41], s[100:101] op_sel:[0,0] op_sel_hi:[1,0]
    v_pk_mul_f32 v[142:143], v[42:43], s[100:101] op_sel:[0,0] op_sel_hi:[1,0]
    v_exp_f32 v136, v136 clamp
    v_exp_f32 v137, v137 clamp
    v_exp_f32 v138, v138 clamp
    v_exp_f32 v139, v139 clamp
    v_exp_f32 v140, v140 clamp
    v_exp_f32 v141, v141 clamp
    v_exp_f32 v142, v142 clamp
    v_exp_f32 v143, v143 clamp
    v_max_f32 v144, v160, v36
    v_max_f32 v145, v160, v37
    v_max_f32 v146, v160, v38
    v_max_f32 v147, v160, v39
    v_max_f32 v148, v160, v40
    v_max_f32 v149, v160, v41
    v_max_f32 v150, v160, v42
    v_max_f32 v151, v160, v43
    v_pk_add_f32 v[136:137], v[136:137], v[144:145] op_sel:[0,0] op_sel_hi:[1,1]
    v_pk_add_f32 v[138:139], v[138:139], v[146:147] op_sel:[0,0] op_sel_hi:[1,1]
    v_pk_add_f32 v[140:141], v[140:141], v[148:149] op_sel:[0,0] op_sel_hi:[1,1]
    v_pk_add_f32 v[142:143], v[142:143], v[150:151] op_sel:[0,0] op_sel_hi:[1,1]
    v_cvt_pk_bf16_f32 v218, v136, v137
    v_cvt_pk_bf16_f32 v219, v138, v139
    v_cvt_pk_bf16_f32 v222, v140, v141
    v_cvt_pk_bf16_f32 v223, v142, v143
    v_pk_fma_f32 v[136:137], v[242:243], v[132:133], v[160:161] op_sel:[0,0,0] op_sel_hi:[0,1,0]
    v_pk_fma_f32 v[138:139], v[242:243], v[134:135], v[160:161] op_sel:[0,0,0] op_sel_hi:[0,1,0]
    v_pk_fma_f32 v[140:141], v[246:247], v[132:133], v[160:161] op_sel:[0,0,0] op_sel_hi:[0,1,0]
    v_pk_fma_f32 v[142:143], v[246:247], v[134:135], v[160:161] op_sel:[0,0,0] op_sel_hi:[0,1,0]
    v_pk_fma_f32 v[52:53], v[240:241], v[52:53], v[136:137] op_sel:[0,0,0] op_sel_hi:[0,1,1]
    v_pk_fma_f32 v[54:55], v[240:241], v[54:55], v[138:139] op_sel:[0,0,0] op_sel_hi:[0,1,1]
    v_pk_fma_f32 v[56:57], v[244:245], v[56:57], v[140:141] op_sel:[0,0,0] op_sel_hi:[0,1,1]
    v_pk_fma_f32 v[58:59], v[244:245], v[58:59], v[142:143] op_sel:[0,0,0] op_sel_hi:[0,1,1]
    v_pk_mul_f32 v[136:137], v[52:53], s[100:101] op_sel:[0,0] op_sel_hi:[1,0]
    v_pk_mul_f32 v[138:139], v[54:55], s[100:101] op_sel:[0,0] op_sel_hi:[1,0]
    v_pk_mul_f32 v[140:141], v[56:57], s[100:101] op_sel:[0,0] op_sel_hi:[1,0]
    v_pk_mul_f32 v[142:143], v[58:59], s[100:101] op_sel:[0,0] op_sel_hi:[1,0]
    v_exp_f32 v136, v136 clamp
    v_exp_f32 v137, v137 clamp
    v_exp_f32 v138, v138 clamp
    v_exp_f32 v139, v139 clamp
    v_exp_f32 v140, v140 clamp
    v_exp_f32 v141, v141 clamp
    v_exp_f32 v142, v142 clamp
    v_exp_f32 v143, v143 clamp
    v_max_f32 v144, v160, v52
    v_max_f32 v145, v160, v53
    v_max_f32 v146, v160, v54
    v_max_f32 v147, v160, v55
    v_max_f32 v148, v160, v56
    v_max_f32 v149, v160, v57
    v_max_f32 v150, v160, v58
    v_max_f32 v151, v160, v59
    v_pk_add_f32 v[136:137], v[136:137], v[144:145] op_sel:[0,0] op_sel_hi:[1,1]
    v_pk_add_f32 v[138:139], v[138:139], v[146:147] op_sel:[0,0] op_sel_hi:[1,1]
    v_pk_add_f32 v[140:141], v[140:141], v[148:149] op_sel:[0,0] op_sel_hi:[1,1]
    v_pk_add_f32 v[142:143], v[142:143], v[150:151] op_sel:[0,0] op_sel_hi:[1,1]
    v_cvt_pk_bf16_f32 v228, v136, v137
    v_cvt_pk_bf16_f32 v229, v138, v139
    v_cvt_pk_bf16_f32 v230, v140, v141
    v_cvt_pk_bf16_f32 v231, v142, v143
    s_waitcnt vmcnt(0)
    v_mov_b32 v4, 89096
    v_mov_b32 v5, 1
    s_mov_b64 exec, 1
    ds_add_u32 v4, v5
    s_mov_b64 exec, -1
    s_mul_i32 s71, s69, 90112
    s_add_u32 s71, s71, 40960
    v_lshl_add_u32 v252, v1, 4, s71
    v_lshl_add_u32 v253, v1, 3, s71
    s_lshl_b32 s71, s68, 6
    s_lshl_b32 s72, s69, 5
    s_add_u32 s71, s71, s72
    v_add_u32 v204, s71, v248
    v_xor_b32 v205, 32, v204
    s_mul_i32 s71, s69, 80
    s_add_u32 s71, s71, 135168
    v_mul_u32_u24 v204, 168, v204
    v_add_u32 v204, s71, v204
    v_lshl_add_u32 v206, v249, 1, v204
    v_lshl_add_u32 v204, v249, 3, v204
    v_mul_u32_u24 v205, 168, v205
    v_add_u32 v205, s71, v205
    v_lshl_add_u32 v207, v249, 1, v205
    v_lshl_add_u32 v205, v249, 3, v205
Lp2:
    v_lshlrev_b32 v2, 4, v1
    v_lshlrev_b32 v3, 3, v1
    s_mul_i32 s70, s69, 10240
    v_add_u32 v4, s70, v2
    s_add_u32 s70, s70, 45056
    v_add_u32 v5, s70, v2
    s_add_u32 s70, s70, 45056
    v_add_u32 v6, s70, v2
    s_add_u32 s28, s74, 0
    s_and_b32 s28, s28, 3
    s_mul_i32 s28, s28, 3
    s_add_u32 s28, s28, 1
    s_lshl_b32 s28, s28, 11
    s_add_u32 s28, s28, s78
    s_add_u32 s29, s74, 1
    s_and_b32 s29, s29, 3
    s_mul_i32 s29, s29, 3
    s_add_u32 s29, s29, 1
    s_lshl_b32 s29, s29, 11
    s_add_u32 s29, s29, s78
    s_add_u32 s30, s74, 2
    s_and_b32 s30, s30, 3
    s_mul_i32 s30, s30, 3
    s_add_u32 s30, s30, 1
    s_lshl_b32 s30, s30, 11
    s_add_u32 s30, s30, s78
    s_add_u32 s31, s74, 3
    s_and_b32 s31, s31, 3
    s_mul_i32 s31, s31, 3
    s_add_u32 s31, s31, 1
    s_lshl_b32 s31, s31, 11
    s_add_u32 s31, s31, s78
    s_add_u32 s32, s74, 4
    s_and_b32 s32, s32, 3
    s_mul_i32 s32, s32, 3
    s_add_u32 s32, s32, 2
    s_lshl_b32 s32, s32, 11
    s_add_u32 s32, s32, s78
    s_add_u32 s33, s74, 5
    s_and_b32 s33, s33, 3
    s_mul_i32 s33, s33, 3
    s_add_u32 s33, s33, 2
    s_lshl_b32 s33, s33, 11
    s_add_u32 s33, s33, s78
    s_add_u32 s34, s74, 6
    s_and_b32 s34, s34, 3
    s_mul_i32 s34, s34, 3
    s_add_u32 s34, s34, 2
    s_lshl_b32 s34, s34, 11
    s_add_u32 s34, s34, s78
    s_add_u32 s35, s74, 7
    s_and_b32 s35, s35, 3
    s_mul_i32 s35, s35, 3
    s_add_u32 s35, s35, 2
    s_lshl_b32 s35, s35, 11
    s_add_u32 s35, s35, s78
    s_add_u32 s36, s74, 8
    s_and_b32 s36, s36, 3
    s_mul_i32 s36, s36, 3
    s_lshl_b32 s36, s36, 11
    s_add_u32 s36, s36, s78
    s_add_u32 s37, s74, 9
    s_and_b32 s37, s37, 3
    s_mul_i32 s37, s37, 3
    s_lshl_b32 s37, s37, 11
    s_add_u32 s37, s37, s78
    s_add_u32 s38, s74, 10
    s_and_b32 s38, s38, 3
    s_mul_i32 s38, s38, 3
    s_lshl_b32 s38, s38, 11
    s_add_u32 s38, s38, s78
    s_add_u32 s39, s74, 11
    s_and_b32 s39, s39, 3
    s_mul_i32 s39, s39, 3
    s_lshl_b32 s39, s39, 11
    s_add_u32 s39, s39, s78
    s_add_u32 s40, s79, 0
    s_add_u32 s12, s3, 0
    s_add_u32 s41, s79, 2560
    s_add_u32 s13, s3, 2560
    s_add_u32 s42, s79, 5120
    s_add_u32 s14, s3, 5120
    s_add_u32 s43, s79, 7680
    s_add_u32 s15, s3, 7680
    s_sub_u32 s70, s66, s78
    s_max_i32 s72, s70, 0
    v_add_u32 v251, s72, v2
    s_sub_u32 s72, s72, s70
    v_add_u32 v250, s72, v2
    s_sub_u32 s28, s28, s72
    s_sub_u32 s29, s29, s72
    s_sub_u32 s30, s30, s72
    s_sub_u32 s31, s31, s72
    s_sub_u32 s32, s32, s72
    s_sub_u32 s33, s33, s72
    s_sub_u32 s34, s34, s72
    s_sub_u32 s35, s35, s72
    s_sub_u32 s36, s36, s72
    s_sub_u32 s37, s37, s72
    s_sub_u32 s38, s38, s72
    s_sub_u32 s39, s39, s72
    v_mov_b32 v255, 0xffff0000
    v_lshlrev_b32 v9, 3, v249
    v_add_u32 v9, 89344, v9
    ds_read_b64 v[52:53], v9 offset:0
    ds_read_b64 v[54:55], v9 offset:32
    ds_read_b64 v[56:57], v9 offset:64
    ds_read_b64 v[58:59], v9 offset:96
    ds_read_b64 v[60:61], v9 offset:128
    s_sub_u32 s70, s60, 4
    s_xor_b32 s71, s70, 2
    s_mul_i32 s70, s70, 5120
    s_mul_i32 s71, s71, 5120
    s_add_u32 s70, s70, 20480
    s_add_u32 s71, s71, 20480
    v_add_u32 v7, s70, v2
    v_add_u32 v254, s71, v2
    s_lshl_b32 s70, s68, 5
    s_lshl_b32 s71, s69, 4
    s_add_u32 s70, s70, s71
    v_add_u32 v10, s70, v248
    v_mul_u32_u24 v8, 160, v10
    v_lshl_add_u32 v8, v249, 3, v8
    v_add_u32 v8, 135168, v8
    v_mul_u32_u24 v10, 168, v10
    v_lshl_add_u32 v10, v249, 3, v10
    s_waitcnt lgkmcnt(0)
    v_add_u32 v9, 145408, v10
    v_lshlrev_b32 v12, 16, v52
    v_and_b32 v13, v255, v52
    v_lshlrev_b32 v14, 16, v53
    v_and_b32 v15, v255, v53
    v_lshlrev_b32 v16, 16, v54
    v_and_b32 v17, v255, v54
    v_lshlrev_b32 v18, 16, v55
    v_and_b32 v19, v255, v55
    v_lshlrev_b32 v20, 16, v56
    v_and_b32 v21, v255, v56
    v_lshlrev_b32 v22, 16, v57
    v_and_b32 v23, v255, v57
    v_lshlrev_b32 v24, 16, v58
    v_and_b32 v25, v255, v58
    v_lshlrev_b32 v26, 16, v59
    v_and_b32 v27, v255, v59
    v_lshlrev_b32 v28, 16, v60
    v_and_b32 v29, v255, v60
    v_lshlrev_b32 v30, 16, v61
    v_and_b32 v31, v255, v61
    s_mov_b32 s52, s20
    s_and_b32 s53, s21, 0xffff
    s_mov_b32 s54, 0x280000
    s_mov_b32 s55, 0x20000
    v_mov_b32 v248, v0
    v_mul_u32_u24 v249, 6554, v248
    v_lshrrev_b32 v249, 16, v249
    v_lshlrev_b32 v248, 4, v248
    v_mad_u32_u24 v10, v249, 8, v248
    v_mul_u32_u24 v249, 1120, v249
    v_add_u32 v249, v249, v248
    v_add_u32 v248, 145408, v10
    s_mul_i32 s83, s64, 81920
    s_mul_i32 s71, s65, 160
    s_add_u32 s83, s83, s71
    v_mov_b32 v10, 0xbfb8aa3b
    s_setprio 0
    s_barrier
    buffer_load_dwordx4 v[132:135], v250, s[44:47], s28 offen offset:0 sc1
    buffer_load_dwordx4 v[136:139], v251, s[44:47], s28 offen offset:0 sc1
    buffer_load_dwordx4 v[140:143], v250, s[44:47], s28 offen offset:1024 sc1
    buffer_load_dwordx4 v[144:147], v251, s[44:47], s28 offen offset:1024 sc1
    ds_read_b128 v[92:95], v5 offset:0
    ds_read_b128 v[96:99], v5 offset:1024
    ds_read_b128 v[100:103], v5 offset:2048
    ds_read_b128 v[104:107], v5 offset:3072
    ds_read_b128 v[108:111], v5 offset:4096
    ds_read_b128 v[112:115], v5 offset:5120
    ds_read_b128 v[116:119], v5 offset:6144
    ds_read_b128 v[120:123], v5 offset:7168
    ds_read_b128 v[124:127], v5 offset:8192
    ds_read_b128 v[128:131], v5 offset:9216
    s_waitcnt vmcnt(0)
    s_waitcnt lgkmcnt(5)
    v_mfma_f32_16x16x32_bf16 v[12:15], v[92:95], v[132:135], v[12:15]
    buffer_load_dwordx4 v[148:151], v250, s[44:47], s29 offen offset:0 sc1
    v_mfma_f32_16x16x32_bf16 v[32:35], v[92:95], v[136:139], 0
    ds_read_b128 v[92:95], v5 offset:20480
    v_mfma_f32_16x16x32_bf16 v[16:19], v[96:99], v[132:135], v[16:19]
    v_mfma_f32_16x16x32_bf16 v[36:39], v[96:99], v[136:139], 0
    ds_read_b128 v[96:99], v5 offset:21504
    buffer_load_dwordx4 v[152:155], v251, s[44:47], s29 offen offset:0 sc1
    v_mfma_f32_16x16x32_bf16 v[20:23], v[100:103], v[132:135], v[20:23]
    v_mfma_f32_16x16x32_bf16 v[40:43], v[100:103], v[136:139], 0
    ds_read_b128 v[100:103], v5 offset:22528
    buffer_load_dwordx4 v[156:159], v250, s[44:47], s29 offen offset:1024 sc1
    v_mfma_f32_16x16x32_bf16 v[24:27], v[104:107], v[132:135], v[24:27]
    v_mfma_f32_16x16x32_bf16 v[44:47], v[104:107], v[136:139], 0
    ds_read_b128 v[104:107], v5 offset:23552
    v_mfma_f32_16x16x32_bf16 v[28:31], v[108:111], v[132:135], v[28:31]
    buffer_load_dwordx4 v[160:163], v251, s[44:47], s29 offen offset:1024 sc1
    v_mfma_f32_16x16x32_bf16 v[48:51], v[108:111], v[136:139], 0
    ds_read_b128 v[108:111], v5 offset:24576
    s_waitcnt lgkmcnt(5)
    s_barrier
    v_mfma_f32_16x16x32_bf16 v[12:15], v[112:115], v[140:143], v[12:15]
    buffer_load_dwordx4 v[164:167], v250, s[44:47], s30 offen offset:0 sc1
    v_mfma_f32_16x16x32_bf16 v[32:35], v[112:115], v[144:147], v[32:35]
    ds_read_b128 v[112:115], v5 offset:25600
    v_mfma_f32_16x16x32_bf16 v[16:19], v[116:119], v[140:143], v[16:19]
    v_mfma_f32_16x16x32_bf16 v[36:39], v[116:119], v[144:147], v[36:39]
    ds_read_b128 v[116:119], v5 offset:26624
    buffer_load_dwordx4 v[168:171], v251, s[44:47], s30 offen offset:0 sc1
    v_mfma_f32_16x16x32_bf16 v[20:23], v[120:123], v[140:143], v[20:23]
    v_mfma_f32_16x16x32_bf16 v[40:43], v[120:123], v[144:147], v[40:43]
    ds_read_b128 v[120:123], v5 offset:27648
    buffer_load_dwordx4 v[172:175], v250, s[44:47], s30 offen offset:1024 sc1
    v_mfma_f32_16x16x32_bf16 v[24:27], v[124:127], v[140:143], v[24:27]
    v_mfma_f32_16x16x32_bf16 v[44:47], v[124:127], v[144:147], v[44:47]
    ds_read_b128 v[124:127], v5 offset:28672
    v_mfma_f32_16x16x32_bf16 v[28:31], v[128:131], v[140:143], v[28:31]
    buffer_load_dwordx4 v[176:179], v251, s[44:47], s30 offen offset:1024 sc1
    v_mfma_f32_16x16x32_bf16 v[48:51], v[128:131], v[144:147], v[48:51]
    ds_read_b128 v[128:131], v5 offset:29696
    s_waitcnt vmcnt(6) lgkmcnt(5)
    v_mfma_f32_16x16x32_bf16 v[12:15], v[92:95], v[148:151], v[12:15]
    buffer_load_dwordx4 v[180:183], v250, s[44:47], s31 offen offset:0 sc1
    v_mfma_f32_16x16x32_bf16 v[32:35], v[92:95], v[152:155], v[32:35]
    ds_read_b128 v[92:95], v6 offset:0
    v_mfma_f32_16x16x32_bf16 v[16:19], v[96:99], v[148:151], v[16:19]
    v_mfma_f32_16x16x32_bf16 v[36:39], v[96:99], v[152:155], v[36:39]
    ds_read_b128 v[96:99], v6 offset:1024
    buffer_load_dwordx4 v[184:187], v251, s[44:47], s31 offen offset:0 sc1
    v_mfma_f32_16x16x32_bf16 v[20:23], v[100:103], v[148:151], v[20:23]
    v_mfma_f32_16x16x32_bf16 v[40:43], v[100:103], v[152:155], v[40:43]
    ds_read_b128 v[100:103], v6 offset:2048
    buffer_load_dwordx4 v[188:191], v250, s[44:47], s31 offen offset:1024 sc1
    v_mfma_f32_16x16x32_bf16 v[24:27], v[104:107], v[148:151], v[24:27]
    v_mfma_f32_16x16x32_bf16 v[44:47], v[104:107], v[152:155], v[44:47]
    ds_read_b128 v[104:107], v6 offset:3072
    v_mfma_f32_16x16x32_bf16 v[28:31], v[108:111], v[148:151], v[28:31]
    buffer_load_dwordx4 v[192:195], v251, s[44:47], s31 offen offset:1024 sc1
    v_mfma_f32_16x16x32_bf16 v[48:51], v[108:111], v[152:155], v[48:51]
    ds_read_b128 v[108:111], v6 offset:4096
    s_waitcnt vmcnt(8) lgkmcnt(5)
    s_barrier
    v_mfma_f32_16x16x32_bf16 v[12:15], v[112:115], v[156:159], v[12:15]
    buffer_load_dwordx4 v[132:135], v250, s[44:47], s32 offen offset:0 sc1
    v_mfma_f32_16x16x32_bf16 v[32:35], v[112:115], v[160:163], v[32:35]
    ds_read_b128 v[112:115], v6 offset:5120
    v_mfma_f32_16x16x32_bf16 v[16:19], v[116:119], v[156:159], v[16:19]
    v_mfma_f32_16x16x32_bf16 v[36:39], v[116:119], v[160:163], v[36:39]
    ds_read_b128 v[116:119], v6 offset:6144
    buffer_load_dwordx4 v[136:139], v251, s[44:47], s32 offen offset:0 sc1
    v_mfma_f32_16x16x32_bf16 v[20:23], v[120:123], v[156:159], v[20:23]
    v_mfma_f32_16x16x32_bf16 v[40:43], v[120:123], v[160:163], v[40:43]
    ds_read_b128 v[120:123], v6 offset:7168
    buffer_load_dwordx4 v[140:143], v250, s[44:47], s32 offen offset:1024 sc1
    v_mfma_f32_16x16x32_bf16 v[24:27], v[124:127], v[156:159], v[24:27]
    v_mfma_f32_16x16x32_bf16 v[44:47], v[124:127], v[160:163], v[44:47]
    ds_read_b128 v[124:127], v6 offset:8192
    v_mfma_f32_16x16x32_bf16 v[28:31], v[128:131], v[156:159], v[28:31]
    buffer_load_dwordx4 v[144:147], v251, s[44:47], s32 offen offset:1024 sc1
    v_mfma_f32_16x16x32_bf16 v[48:51], v[128:131], v[160:163], v[48:51]
    ds_read_b128 v[128:131], v6 offset:9216
    s_waitcnt vmcnt(10) lgkmcnt(5)
    v_mfma_f32_16x16x32_bf16 v[12:15], v[92:95], v[164:167], v[12:15]
    buffer_load_dwordx4 v[148:151], v250, s[44:47], s33 offen offset:0 sc1
    v_mfma_f32_16x16x32_bf16 v[32:35], v[92:95], v[168:171], v[32:35]
    ds_read_b128 v[92:95], v6 offset:20480
    v_mfma_f32_16x16x32_bf16 v[16:19], v[96:99], v[164:167], v[16:19]
    v_mfma_f32_16x16x32_bf16 v[36:39], v[96:99], v[168:171], v[36:39]
    ds_read_b128 v[96:99], v6 offset:21504
    buffer_load_dwordx4 v[152:155], v251, s[44:47], s33 offen offset:0 sc1
    v_mfma_f32_16x16x32_bf16 v[20:23], v[100:103], v[164:167], v[20:23]
    v_mfma_f32_16x16x32_bf16 v[40:43], v[100:103], v[168:171], v[40:43]
    ds_read_b128 v[100:103], v6 offset:22528
    buffer_load_dwordx4 v[156:159], v250, s[44:47], s33 offen offset:1024 sc1
    v_mfma_f32_16x16x32_bf16 v[24:27], v[104:107], v[164:167], v[24:27]
    v_mfma_f32_16x16x32_bf16 v[44:47], v[104:107], v[168:171], v[44:47]
    ds_read_b128 v[104:107], v6 offset:23552
    v_mfma_f32_16x16x32_bf16 v[28:31], v[108:111], v[164:167], v[28:31]
    buffer_load_dwordx4 v[160:163], v251, s[44:47], s33 offen offset:1024 sc1
    v_mfma_f32_16x16x32_bf16 v[48:51], v[108:111], v[168:171], v[48:51]
    ds_read_b128 v[108:111], v6 offset:24576
    s_cmp_eq_u32 s63, 0
    s_cbranch_scc1 Lok
    s_waitcnt vmcnt(12) lgkmcnt(5)
    s_barrier
    ds_read_b64 v[244:245], v253 offset:3072
    ds_read_b64 v[246:247], v253 offset:3584
    ds_read_b128 v[236:239], v252 offset:1024
    ds_read_b128 v[240:243], v252 offset:2048
    ds_read_b128 v[232:235], v252 offset:0
    v_mfma_f32_16x16x32_bf16 v[12:15], v[112:115], v[172:175], v[12:15]
    buffer_load_dwordx4 v[164:167], v250, s[44:47], s34 offen offset:0 sc1
    v_mfma_f32_16x16x32_bf16 v[32:35], v[112:115], v[176:179], v[32:35]
    ds_read_b128 v[112:115], v6 offset:25600
    v_mfma_f32_16x16x32_bf16 v[16:19], v[116:119], v[172:175], v[16:19]
    v_mfma_f32_16x16x32_bf16 v[36:39], v[116:119], v[176:179], v[36:39]
    ds_read_b128 v[116:119], v6 offset:26624
    v_mfma_f32_16x16x32_bf16 v[20:23], v[120:123], v[172:175], v[20:23]
    v_mfma_f32_16x16x32_bf16 v[40:43], v[120:123], v[176:179], v[40:43]
    ds_read_b128 v[120:123], v6 offset:27648
    buffer_load_dwordx4 v[168:171], v251, s[44:47], s34 offen offset:0 sc1
    v_mfma_f32_16x16x32_bf16 v[24:27], v[124:127], v[172:175], v[24:27]
    v_mfma_f32_16x16x32_bf16 v[44:47], v[124:127], v[176:179], v[44:47]
    ds_read_b128 v[124:127], v6 offset:28672
    v_mfma_f32_16x16x32_bf16 v[28:31], v[128:131], v[172:175], v[28:31]
    v_mfma_f32_16x16x32_bf16 v[48:51], v[128:131], v[176:179], v[48:51]
    ds_read_b128 v[128:131], v6 offset:29696
    s_waitcnt lgkmcnt(5)
    v_mfma_f32_16x16x16_bf16 v[56:59], v[244:245], v[224:225], 0
    v_mfma_f32_16x16x16_bf16 v[68:71], v[244:245], v[226:227], 0
    v_mfma_f32_16x16x16_bf16 v[80:83], v[244:245], v[228:229], 0
    v_mfma_f32_16x16x16_bf16 v[196:199], v[244:245], v[230:231], 0
    v_mfma_f32_16x16x16_bf16 v[60:63], v[246:247], v[224:225], 0
    v_mfma_f32_16x16x16_bf16 v[72:75], v[246:247], v[226:227], 0
    v_mfma_f32_16x16x16_bf16 v[84:87], v[246:247], v[228:229], 0
    v_mfma_f32_16x16x16_bf16 v[200:203], v[246:247], v[230:231], 0
    v_mfma_f32_16x16x32_bf16 v[56:59], v[236:239], v[208:211], v[56:59]
    v_mfma_f32_16x16x32_bf16 v[68:71], v[236:239], v[212:215], v[68:71]
    v_mfma_f32_16x16x32_bf16 v[80:83], v[236:239], v[216:219], v[80:83]
    v_mfma_f32_16x16x32_bf16 v[196:199], v[236:239], v[220:223], v[196:199]
    v_mfma_f32_16x16x32_bf16 v[60:63], v[240:243], v[208:211], v[60:63]
    v_mfma_f32_16x16x32_bf16 v[72:75], v[240:243], v[212:215], v[72:75]
    v_mfma_f32_16x16x32_bf16 v[84:87], v[240:243], v[216:219], v[84:87]
    v_mfma_f32_16x16x32_bf16 v[200:203], v[240:243], v[220:223], v[200:203]
    v_mfma_f32_16x16x32_bf16 v[52:55], v[232:235], v[208:211], 0
    v_mfma_f32_16x16x32_bf16 v[64:67], v[232:235], v[212:215], 0
    v_mfma_f32_16x16x32_bf16 v[76:79], v[232:235], v[216:219], 0
    v_mfma_f32_16x16x32_bf16 v[88:91], v[232:235], v[220:223], 0
    s_waitcnt vmcnt(12)
    v_mfma_f32_16x16x32_bf16 v[12:15], v[92:95], v[180:183], v[12:15]
    buffer_load_dwordx4 v[172:175], v250, s[44:47], s34 offen offset:1024 sc1
    v_add_f32 v57, 0x358637bd, v57
    v_add_f32 v58, 0x358637bd, v58
    v_add_f32 v69, 0x358637bd, v69
    v_add_f32 v70, 0x358637bd, v70
    v_add_f32 v81, 0x358637bd, v81
    v_add_f32 v82, 0x358637bd, v82
    v_add_f32 v197, 0x358637bd, v197
    v_add_f32 v198, 0x358637bd, v198
    v_rcp_f32 v57, v57
    v_mfma_f32_16x16x32_bf16 v[32:35], v[92:95], v[184:187], v[32:35]
    ds_read_b128 v[92:95], v4 offset:0
    v_rcp_f32 v58, v58
    v_rcp_f32 v69, v69
    v_rcp_f32 v70, v70
    v_rcp_f32 v81, v81
    v_rcp_f32 v82, v82
    v_rcp_f32 v197, v197
    v_rcp_f32 v198, v198
    v_mul_f32 v60, v60, v58
    v_mul_f32 v61, v61, v58
    v_mfma_f32_16x16x32_bf16 v[16:19], v[96:99], v[180:183], v[16:19]
    v_mul_f32 v62, v62, v58
    v_mul_f32 v63, v63, v58
    v_mul_f32 v59, v59, v58
    v_mul_f32 v56, v56, v57
    v_cvt_pk_bf16_f32 v60, v60, v61
    v_cvt_pk_bf16_f32 v61, v62, v63
    v_cvt_pk_bf16_f32 v56, v56, v59
    ds_write_b64 v204, v[60:61] offset:40
    v_mul_f32 v52, v52, v57
    v_mfma_f32_16x16x32_bf16 v[36:39], v[96:99], v[184:187], v[36:39]
    ds_read_b128 v[96:99], v4 offset:1024
    v_mul_f32 v53, v53, v57
    v_mul_f32 v54, v54, v57
    v_mul_f32 v55, v55, v57
    ds_write_b16 v206, v56 offset:32
    ds_write_b16_d16_hi v206, v56 offset:72
    v_cvt_pk_bf16_f32 v52, v52, v53
    v_cvt_pk_bf16_f32 v53, v54, v55
    ds_write_b64 v204, v[52:53] offset:0
    v_mul_f32 v72, v72, v70
    v_mfma_f32_16x16x32_bf16 v[20:23], v[100:103], v[180:183], v[20:23]
    v_mul_f32 v73, v73, v70
    v_mul_f32 v74, v74, v70
    v_mul_f32 v75, v75, v70
    v_mul_f32 v71, v71, v70
    v_mul_f32 v68, v68, v69
    v_cvt_pk_bf16_f32 v72, v72, v73
    v_cvt_pk_bf16_f32 v73, v74, v75
    v_cvt_pk_bf16_f32 v68, v68, v71
    ds_write_b64 v204, v[72:73] offset:2728
    v_mul_f32 v64, v64, v69
    v_mfma_f32_16x16x32_bf16 v[40:43], v[100:103], v[184:187], v[40:43]
    ds_read_b128 v[100:103], v4 offset:2048
    buffer_load_dwordx4 v[176:179], v251, s[44:47], s34 offen offset:1024 sc1
    v_mul_f32 v65, v65, v69
    v_mul_f32 v66, v66, v69
    v_mul_f32 v67, v67, v69
    ds_write_b16 v206, v68 offset:2720
    ds_write_b16_d16_hi v206, v68 offset:2760
    v_cvt_pk_bf16_f32 v64, v64, v65
    v_cvt_pk_bf16_f32 v65, v66, v67
    ds_write_b64 v204, v[64:65] offset:2688
    v_mul_f32 v84, v84, v82
    v_mfma_f32_16x16x32_bf16 v[24:27], v[104:107], v[180:183], v[24:27]
    v_mul_f32 v85, v85, v82
    v_mul_f32 v86, v86, v82
    v_mul_f32 v87, v87, v82
    v_mul_f32 v83, v83, v82
    v_mul_f32 v80, v80, v81
    v_cvt_pk_bf16_f32 v84, v84, v85
    v_cvt_pk_bf16_f32 v85, v86, v87
    v_cvt_pk_bf16_f32 v80, v80, v83
    ds_write_b64 v205, v[84:85] offset:40
    v_mfma_f32_16x16x32_bf16 v[44:47], v[104:107], v[184:187], v[44:47]
    ds_read_b128 v[104:107], v4 offset:3072
    v_mul_f32 v76, v76, v81
    v_mul_f32 v77, v77, v81
    v_mul_f32 v78, v78, v81
    v_mul_f32 v79, v79, v81
    ds_write_b16 v207, v80 offset:32
    ds_write_b16_d16_hi v207, v80 offset:72
    v_cvt_pk_bf16_f32 v76, v76, v77
    v_cvt_pk_bf16_f32 v77, v78, v79
    ds_write_b64 v205, v[76:77] offset:0
    v_mfma_f32_16x16x32_bf16 v[28:31], v[108:111], v[180:183], v[28:31]
    v_mul_f32 v200, v200, v198
    v_mul_f32 v201, v201, v198
    v_mul_f32 v202, v202, v198
    v_mul_f32 v203, v203, v198
    v_mul_f32 v199, v199, v198
    v_mul_f32 v196, v196, v197
    v_cvt_pk_bf16_f32 v200, v200, v201
    v_cvt_pk_bf16_f32 v201, v202, v203
    v_cvt_pk_bf16_f32 v196, v196, v199
    v_mfma_f32_16x16x32_bf16 v[48:51], v[108:111], v[184:187], v[48:51]
    ds_read_b128 v[108:111], v4 offset:4096
    ds_write_b64 v205, v[200:201] offset:2728
    v_mul_f32 v88, v88, v197
    v_mul_f32 v89, v89, v197
    v_mul_f32 v90, v90, v197
    v_mul_f32 v91, v91, v197
    ds_write_b16 v207, v196 offset:2720
    ds_write_b16_d16_hi v207, v196 offset:2760
    v_cvt_pk_bf16_f32 v88, v88, v89
    v_cvt_pk_bf16_f32 v89, v90, v91
    ds_write_b64 v205, v[88:89] offset:2688
    s_waitcnt lgkmcnt(0)
Loj:
    s_waitcnt vmcnt(12) lgkmcnt(5)
    s_barrier
    v_mfma_f32_16x16x32_bf16 v[12:15], v[112:115], v[188:191], v[12:15]
    buffer_load_dwordx4 v[180:183], v250, s[44:47], s35 offen offset:0 sc1
    v_mfma_f32_16x16x32_bf16 v[32:35], v[112:115], v[192:195], v[32:35]
    ds_read_b128 v[112:115], v4 offset:5120
    v_mfma_f32_16x16x32_bf16 v[16:19], v[116:119], v[188:191], v[16:19]
    v_mfma_f32_16x16x32_bf16 v[36:39], v[116:119], v[192:195], v[36:39]
    ds_read_b128 v[116:119], v4 offset:6144
    v_mfma_f32_16x16x32_bf16 v[20:23], v[120:123], v[188:191], v[20:23]
    v_mfma_f32_16x16x32_bf16 v[40:43], v[120:123], v[192:195], v[40:43]
    ds_read_b128 v[120:123], v4 offset:7168
    buffer_load_dwordx4 v[184:187], v251, s[44:47], s35 offen offset:0 sc1
    v_mfma_f32_16x16x32_bf16 v[24:27], v[124:127], v[188:191], v[24:27]
    v_mfma_f32_16x16x32_bf16 v[44:47], v[124:127], v[192:195], v[44:47]
    ds_read_b128 v[124:127], v4 offset:8192
    v_mfma_f32_16x16x32_bf16 v[28:31], v[128:131], v[188:191], v[28:31]
    v_mfma_f32_16x16x32_bf16 v[48:51], v[128:131], v[192:195], v[48:51]
    ds_read_b128 v[128:131], v4 offset:9216
    s_waitcnt vmcnt(12) lgkmcnt(5)
    v_mfma_f32_16x16x32_bf16 v[12:15], v[92:95], v[132:135], v[12:15]
    buffer_load_dwordx4 v[188:191], v250, s[44:47], s35 offen offset:1024 sc1
    v_mfma_f32_16x16x32_bf16 v[32:35], v[92:95], v[136:139], v[32:35]
    ds_read_b128 v[92:95], v4 offset:20480
    v_mfma_f32_16x16x32_bf16 v[16:19], v[96:99], v[132:135], v[16:19]
    v_mfma_f32_16x16x32_bf16 v[36:39], v[96:99], v[136:139], v[36:39]
    ds_read_b128 v[96:99], v4 offset:21504
    v_mfma_f32_16x16x32_bf16 v[20:23], v[100:103], v[132:135], v[20:23]
    v_mfma_f32_16x16x32_bf16 v[40:43], v[100:103], v[136:139], v[40:43]
    ds_read_b128 v[100:103], v4 offset:22528
    buffer_load_dwordx4 v[192:195], v251, s[44:47], s35 offen offset:1024 sc1
    v_mfma_f32_16x16x32_bf16 v[24:27], v[104:107], v[132:135], v[24:27]
    v_mfma_f32_16x16x32_bf16 v[44:47], v[104:107], v[136:139], v[44:47]
    ds_read_b128 v[104:107], v4 offset:23552
    v_mfma_f32_16x16x32_bf16 v[28:31], v[108:111], v[132:135], v[28:31]
    v_mfma_f32_16x16x32_bf16 v[48:51], v[108:111], v[136:139], v[48:51]
    ds_read_b128 v[108:111], v4 offset:24576
    s_waitcnt vmcnt(12) lgkmcnt(5)
    s_barrier
    v_mfma_f32_16x16x32_bf16 v[12:15], v[112:115], v[140:143], v[12:15]
    buffer_load_dwordx4 v[132:135], v250, s[44:47], s36 offen offset:0 sc1
    v_mfma_f32_16x16x32_bf16 v[32:35], v[112:115], v[144:147], v[32:35]
    ds_read_b128 v[112:115], v4 offset:25600
    v_mfma_f32_16x16x32_bf16 v[16:19], v[116:119], v[140:143], v[16:19]
    v_mfma_f32_16x16x32_bf16 v[36:39], v[116:119], v[144:147], v[36:39]
    ds_read_b128 v[116:119], v4 offset:26624
    v_mfma_f32_16x16x32_bf16 v[20:23], v[120:123], v[140:143], v[20:23]
    v_mfma_f32_16x16x32_bf16 v[40:43], v[120:123], v[144:147], v[40:43]
    ds_read_b128 v[120:123], v4 offset:27648
    buffer_load_dwordx4 v[136:139], v251, s[44:47], s36 offen offset:0 sc1
    v_mfma_f32_16x16x32_bf16 v[24:27], v[124:127], v[140:143], v[24:27]
    v_mfma_f32_16x16x32_bf16 v[44:47], v[124:127], v[144:147], v[44:47]
    ds_read_b128 v[124:127], v4 offset:28672
    v_mfma_f32_16x16x32_bf16 v[28:31], v[128:131], v[140:143], v[28:31]
    v_mfma_f32_16x16x32_bf16 v[48:51], v[128:131], v[144:147], v[48:51]
    ds_read_b128 v[128:131], v4 offset:29696
    s_waitcnt vmcnt(12) lgkmcnt(5)
    v_mfma_f32_16x16x32_bf16 v[12:15], v[92:95], v[148:151], v[12:15]
    buffer_load_dwordx4 v[140:143], v250, s[44:47], s36 offen offset:1024 sc1
    v_mfma_f32_16x16x32_bf16 v[32:35], v[92:95], v[152:155], v[32:35]
    ds_read_b128 v[92:95], v5 offset:0
    v_mfma_f32_16x16x32_bf16 v[16:19], v[96:99], v[148:151], v[16:19]
    v_mfma_f32_16x16x32_bf16 v[36:39], v[96:99], v[152:155], v[36:39]
    ds_read_b128 v[96:99], v5 offset:1024
    v_mfma_f32_16x16x32_bf16 v[20:23], v[100:103], v[148:151], v[20:23]
    v_mfma_f32_16x16x32_bf16 v[40:43], v[100:103], v[152:155], v[40:43]
    ds_read_b128 v[100:103], v5 offset:2048
    buffer_load_dwordx4 v[144:147], v251, s[44:47], s36 offen offset:1024 sc1
    v_mfma_f32_16x16x32_bf16 v[24:27], v[104:107], v[148:151], v[24:27]
    v_mfma_f32_16x16x32_bf16 v[44:47], v[104:107], v[152:155], v[44:47]
    ds_read_b128 v[104:107], v5 offset:3072
    v_mfma_f32_16x16x32_bf16 v[28:31], v[108:111], v[148:151], v[28:31]
    v_mfma_f32_16x16x32_bf16 v[48:51], v[108:111], v[152:155], v[48:51]
    ds_read_b128 v[108:111], v5 offset:4096
    s_waitcnt vmcnt(12) lgkmcnt(5)
    s_barrier
    v_mfma_f32_16x16x32_bf16 v[12:15], v[112:115], v[156:159], v[12:15]
    buffer_load_dwordx4 v[148:151], v250, s[44:47], s37 offen offset:0 sc1
    v_mfma_f32_16x16x32_bf16 v[32:35], v[112:115], v[160:163], v[32:35]
    ds_read_b128 v[112:115], v5 offset:5120
    v_mfma_f32_16x16x32_bf16 v[16:19], v[116:119], v[156:159], v[16:19]
    v_mfma_f32_16x16x32_bf16 v[36:39], v[116:119], v[160:163], v[36:39]
    ds_read_b128 v[116:119], v5 offset:6144
    v_mfma_f32_16x16x32_bf16 v[20:23], v[120:123], v[156:159], v[20:23]
    v_mfma_f32_16x16x32_bf16 v[40:43], v[120:123], v[160:163], v[40:43]
    ds_read_b128 v[120:123], v5 offset:7168
    buffer_load_dwordx4 v[152:155], v251, s[44:47], s37 offen offset:0 sc1
    v_mfma_f32_16x16x32_bf16 v[24:27], v[124:127], v[156:159], v[24:27]
    v_mfma_f32_16x16x32_bf16 v[44:47], v[124:127], v[160:163], v[44:47]
    ds_read_b128 v[124:127], v5 offset:8192
    v_mfma_f32_16x16x32_bf16 v[28:31], v[128:131], v[156:159], v[28:31]
    v_mfma_f32_16x16x32_bf16 v[48:51], v[128:131], v[160:163], v[48:51]
    ds_read_b128 v[128:131], v5 offset:9216
    s_waitcnt vmcnt(12) lgkmcnt(5)
    v_mfma_f32_16x16x32_bf16 v[12:15], v[92:95], v[164:167], v[12:15]
    buffer_load_dwordx4 v[156:159], v250, s[44:47], s37 offen offset:1024 sc1
    v_mfma_f32_16x16x32_bf16 v[32:35], v[92:95], v[168:171], v[32:35]
    ds_read_b128 v[92:95], v5 offset:20480
    v_mfma_f32_16x16x32_bf16 v[16:19], v[96:99], v[164:167], v[16:19]
    v_mfma_f32_16x16x32_bf16 v[36:39], v[96:99], v[168:171], v[36:39]
    ds_read_b128 v[96:99], v5 offset:21504
    v_mfma_f32_16x16x32_bf16 v[20:23], v[100:103], v[164:167], v[20:23]
    v_mfma_f32_16x16x32_bf16 v[40:43], v[100:103], v[168:171], v[40:43]
    ds_read_b128 v[100:103], v5 offset:22528
    buffer_load_dwordx4 v[160:163], v251, s[44:47], s37 offen offset:1024 sc1
    v_mfma_f32_16x16x32_bf16 v[24:27], v[104:107], v[164:167], v[24:27]
    v_mfma_f32_16x16x32_bf16 v[44:47], v[104:107], v[168:171], v[44:47]
    ds_read_b128 v[104:107], v5 offset:23552
    v_mfma_f32_16x16x32_bf16 v[28:31], v[108:111], v[164:167], v[28:31]
    v_mfma_f32_16x16x32_bf16 v[48:51], v[108:111], v[168:171], v[48:51]
    ds_read_b128 v[108:111], v5 offset:24576
    s_waitcnt vmcnt(12) lgkmcnt(5)
    s_barrier
    v_mfma_f32_16x16x32_bf16 v[12:15], v[112:115], v[172:175], v[12:15]
    buffer_load_dwordx4 v[164:167], v250, s[44:47], s38 offen offset:0 sc1
    v_mfma_f32_16x16x32_bf16 v[32:35], v[112:115], v[176:179], v[32:35]
    ds_read_b128 v[112:115], v5 offset:25600
    v_mfma_f32_16x16x32_bf16 v[16:19], v[116:119], v[172:175], v[16:19]
    v_mfma_f32_16x16x32_bf16 v[36:39], v[116:119], v[176:179], v[36:39]
    ds_read_b128 v[116:119], v5 offset:26624
    v_mfma_f32_16x16x32_bf16 v[20:23], v[120:123], v[172:175], v[20:23]
    v_mfma_f32_16x16x32_bf16 v[40:43], v[120:123], v[176:179], v[40:43]
    ds_read_b128 v[120:123], v5 offset:27648
    buffer_load_dwordx4 v[168:171], v251, s[44:47], s38 offen offset:0 sc1
    v_mfma_f32_16x16x32_bf16 v[24:27], v[124:127], v[172:175], v[24:27]
    v_mfma_f32_16x16x32_bf16 v[44:47], v[124:127], v[176:179], v[44:47]
    ds_read_b128 v[124:127], v5 offset:28672
    v_mfma_f32_16x16x32_bf16 v[28:31], v[128:131], v[172:175], v[28:31]
    v_mfma_f32_16x16x32_bf16 v[48:51], v[128:131], v[176:179], v[48:51]
    ds_read_b128 v[128:131], v5 offset:29696
    s_waitcnt vmcnt(12) lgkmcnt(5)
    v_mfma_f32_16x16x32_bf16 v[12:15], v[92:95], v[180:183], v[12:15]
    buffer_load_dwordx4 v[172:175], v250, s[44:47], s38 offen offset:1024 sc1
    v_mfma_f32_16x16x32_bf16 v[32:35], v[92:95], v[184:187], v[32:35]
    ds_read_b128 v[92:95], v6 offset:0
    v_mfma_f32_16x16x32_bf16 v[16:19], v[96:99], v[180:183], v[16:19]
    v_mfma_f32_16x16x32_bf16 v[36:39], v[96:99], v[184:187], v[36:39]
    ds_read_b128 v[96:99], v6 offset:1024
    v_mfma_f32_16x16x32_bf16 v[20:23], v[100:103], v[180:183], v[20:23]
    v_mfma_f32_16x16x32_bf16 v[40:43], v[100:103], v[184:187], v[40:43]
    ds_read_b128 v[100:103], v6 offset:2048
    buffer_load_dwordx4 v[176:179], v251, s[44:47], s38 offen offset:1024 sc1
    v_mfma_f32_16x16x32_bf16 v[24:27], v[104:107], v[180:183], v[24:27]
    v_mfma_f32_16x16x32_bf16 v[44:47], v[104:107], v[184:187], v[44:47]
    ds_read_b128 v[104:107], v6 offset:3072
    v_mfma_f32_16x16x32_bf16 v[28:31], v[108:111], v[180:183], v[28:31]
    v_mfma_f32_16x16x32_bf16 v[48:51], v[108:111], v[184:187], v[48:51]
    ds_read_b128 v[108:111], v6 offset:4096
    s_waitcnt vmcnt(12) lgkmcnt(5)
    s_barrier
    v_mfma_f32_16x16x32_bf16 v[12:15], v[112:115], v[188:191], v[12:15]
    buffer_load_dwordx4 v[180:183], v250, s[44:47], s39 offen offset:0 sc1
    v_mfma_f32_16x16x32_bf16 v[32:35], v[112:115], v[192:195], v[32:35]
    ds_read_b128 v[112:115], v6 offset:5120
    v_mfma_f32_16x16x32_bf16 v[16:19], v[116:119], v[188:191], v[16:19]
    v_mfma_f32_16x16x32_bf16 v[36:39], v[116:119], v[192:195], v[36:39]
    ds_read_b128 v[116:119], v6 offset:6144
    v_mfma_f32_16x16x32_bf16 v[20:23], v[120:123], v[188:191], v[20:23]
    v_mfma_f32_16x16x32_bf16 v[40:43], v[120:123], v[192:195], v[40:43]
    ds_read_b128 v[120:123], v6 offset:7168
    buffer_load_dwordx4 v[184:187], v251, s[44:47], s39 offen offset:0 sc1
    v_mfma_f32_16x16x32_bf16 v[24:27], v[124:127], v[188:191], v[24:27]
    v_mfma_f32_16x16x32_bf16 v[44:47], v[124:127], v[192:195], v[44:47]
    ds_read_b128 v[124:127], v6 offset:8192
    v_mfma_f32_16x16x32_bf16 v[28:31], v[128:131], v[188:191], v[28:31]
    v_mfma_f32_16x16x32_bf16 v[48:51], v[128:131], v[192:195], v[48:51]
    ds_read_b128 v[128:131], v6 offset:9216
    s_waitcnt vmcnt(12) lgkmcnt(5)
    v_mfma_f32_16x16x32_bf16 v[12:15], v[92:95], v[132:135], v[12:15]
    buffer_load_dwordx4 v[188:191], v250, s[44:47], s39 offen offset:1024 sc1
    v_mfma_f32_16x16x32_bf16 v[32:35], v[92:95], v[136:139], v[32:35]
    ds_read_b128 v[92:95], v6 offset:20480
    v_mfma_f32_16x16x32_bf16 v[16:19], v[96:99], v[132:135], v[16:19]
    v_mfma_f32_16x16x32_bf16 v[36:39], v[96:99], v[136:139], v[36:39]
    ds_read_b128 v[96:99], v6 offset:21504
    v_mfma_f32_16x16x32_bf16 v[20:23], v[100:103], v[132:135], v[20:23]
    v_mfma_f32_16x16x32_bf16 v[40:43], v[100:103], v[136:139], v[40:43]
    ds_read_b128 v[100:103], v6 offset:22528
    buffer_load_dwordx4 v[192:195], v251, s[44:47], s39 offen offset:1024 sc1
    v_mfma_f32_16x16x32_bf16 v[24:27], v[104:107], v[132:135], v[24:27]
    v_mfma_f32_16x16x32_bf16 v[44:47], v[104:107], v[136:139], v[44:47]
    ds_read_b128 v[104:107], v6 offset:23552
    v_mfma_f32_16x16x32_bf16 v[28:31], v[108:111], v[132:135], v[28:31]
    v_mfma_f32_16x16x32_bf16 v[48:51], v[108:111], v[136:139], v[48:51]
    ds_read_b128 v[108:111], v6 offset:24576
    s_waitcnt vmcnt(12) lgkmcnt(5)
    s_barrier
    v_mfma_f32_16x16x32_bf16 v[12:15], v[112:115], v[140:143], v[12:15]
    v_mfma_f32_16x16x32_bf16 v[32:35], v[112:115], v[144:147], v[32:35]
    ds_read_b128 v[112:115], v6 offset:25600
    v_mfma_f32_16x16x32_bf16 v[16:19], v[116:119], v[140:143], v[16:19]
    v_mfma_f32_16x16x32_bf16 v[36:39], v[116:119], v[144:147], v[36:39]
    ds_read_b128 v[116:119], v6 offset:26624
    v_mfma_f32_16x16x32_bf16 v[20:23], v[120:123], v[140:143], v[20:23]
    v_mfma_f32_16x16x32_bf16 v[40:43], v[120:123], v[144:147], v[40:43]
    ds_read_b128 v[120:123], v6 offset:27648
    v_mfma_f32_16x16x32_bf16 v[24:27], v[124:127], v[140:143], v[24:27]
    v_mfma_f32_16x16x32_bf16 v[44:47], v[124:127], v[144:147], v[44:47]
    ds_read_b128 v[124:127], v6 offset:28672
    v_mfma_f32_16x16x32_bf16 v[28:31], v[128:131], v[140:143], v[28:31]
    v_mfma_f32_16x16x32_bf16 v[48:51], v[128:131], v[144:147], v[48:51]
    ds_read_b128 v[128:131], v6 offset:29696
    s_waitcnt vmcnt(10) lgkmcnt(5)
    v_mfma_f32_16x16x32_bf16 v[12:15], v[92:95], v[148:151], v[12:15]
    v_mfma_f32_16x16x32_bf16 v[32:35], v[92:95], v[152:155], v[32:35]
    ds_read_b128 v[92:95], v4 offset:0
    v_mfma_f32_16x16x32_bf16 v[16:19], v[96:99], v[148:151], v[16:19]
    v_mfma_f32_16x16x32_bf16 v[36:39], v[96:99], v[152:155], v[36:39]
    ds_read_b128 v[96:99], v4 offset:1024
    v_mfma_f32_16x16x32_bf16 v[20:23], v[100:103], v[148:151], v[20:23]
    v_mfma_f32_16x16x32_bf16 v[40:43], v[100:103], v[152:155], v[40:43]
    ds_read_b128 v[100:103], v4 offset:2048
    v_mfma_f32_16x16x32_bf16 v[24:27], v[104:107], v[148:151], v[24:27]
    v_mfma_f32_16x16x32_bf16 v[44:47], v[104:107], v[152:155], v[44:47]
    ds_read_b128 v[104:107], v4 offset:3072
    v_mfma_f32_16x16x32_bf16 v[28:31], v[108:111], v[148:151], v[28:31]
    v_mfma_f32_16x16x32_bf16 v[48:51], v[108:111], v[152:155], v[48:51]
    ds_read_b128 v[108:111], v4 offset:4096
    s_waitcnt vmcnt(8) lgkmcnt(5)
    s_barrier
    v_mfma_f32_16x16x32_bf16 v[12:15], v[112:115], v[156:159], v[12:15]
    v_mfma_f32_16x16x32_bf16 v[32:35], v[112:115], v[160:163], v[32:35]
    ds_read_b128 v[112:115], v4 offset:5120
    v_mfma_f32_16x16x32_bf16 v[16:19], v[116:119], v[156:159], v[16:19]
    v_mfma_f32_16x16x32_bf16 v[36:39], v[116:119], v[160:163], v[36:39]
    ds_read_b128 v[116:119], v4 offset:6144
    v_mfma_f32_16x16x32_bf16 v[20:23], v[120:123], v[156:159], v[20:23]
    v_mfma_f32_16x16x32_bf16 v[40:43], v[120:123], v[160:163], v[40:43]
    ds_read_b128 v[120:123], v4 offset:7168
    v_mfma_f32_16x16x32_bf16 v[24:27], v[124:127], v[156:159], v[24:27]
    v_mfma_f32_16x16x32_bf16 v[44:47], v[124:127], v[160:163], v[44:47]
    ds_read_b128 v[124:127], v4 offset:8192
    v_mfma_f32_16x16x32_bf16 v[28:31], v[128:131], v[156:159], v[28:31]
    v_mfma_f32_16x16x32_bf16 v[48:51], v[128:131], v[160:163], v[48:51]
    ds_read_b128 v[128:131], v4 offset:9216
    s_waitcnt vmcnt(6) lgkmcnt(5)
    v_mfma_f32_16x16x32_bf16 v[12:15], v[92:95], v[164:167], v[12:15]
    v_mfma_f32_16x16x32_bf16 v[32:35], v[92:95], v[168:171], v[32:35]
    ds_read_b128 v[92:95], v4 offset:20480
    v_mfma_f32_16x16x32_bf16 v[16:19], v[96:99], v[164:167], v[16:19]
    v_mfma_f32_16x16x32_bf16 v[36:39], v[96:99], v[168:171], v[36:39]
    ds_read_b128 v[96:99], v4 offset:21504
    v_mfma_f32_16x16x32_bf16 v[20:23], v[100:103], v[164:167], v[20:23]
    v_mfma_f32_16x16x32_bf16 v[40:43], v[100:103], v[168:171], v[40:43]
    ds_read_b128 v[100:103], v4 offset:22528
    v_mfma_f32_16x16x32_bf16 v[24:27], v[104:107], v[164:167], v[24:27]
    v_mfma_f32_16x16x32_bf16 v[44:47], v[104:107], v[168:171], v[44:47]
    ds_read_b128 v[104:107], v4 offset:23552
    v_mfma_f32_16x16x32_bf16 v[28:31], v[108:111], v[164:167], v[28:31]
    v_mfma_f32_16x16x32_bf16 v[48:51], v[108:111], v[168:171], v[48:51]
    ds_read_b128 v[108:111], v4 offset:24576
    s_waitcnt vmcnt(4) lgkmcnt(5)
    s_barrier
    v_mfma_f32_16x16x32_bf16 v[12:15], v[112:115], v[172:175], v[12:15]
    v_mfma_f32_16x16x32_bf16 v[32:35], v[112:115], v[176:179], v[32:35]
    ds_read_b128 v[112:115], v4 offset:25600
    v_mfma_f32_16x16x32_bf16 v[16:19], v[116:119], v[172:175], v[16:19]
    v_mfma_f32_16x16x32_bf16 v[36:39], v[116:119], v[176:179], v[36:39]
    ds_read_b128 v[116:119], v4 offset:26624
    v_mfma_f32_16x16x32_bf16 v[20:23], v[120:123], v[172:175], v[20:23]
    v_mfma_f32_16x16x32_bf16 v[40:43], v[120:123], v[176:179], v[40:43]
    ds_read_b128 v[120:123], v4 offset:27648
    v_mfma_f32_16x16x32_bf16 v[24:27], v[124:127], v[172:175], v[24:27]
    v_mfma_f32_16x16x32_bf16 v[44:47], v[124:127], v[176:179], v[44:47]
    ds_read_b128 v[124:127], v4 offset:28672
    v_mfma_f32_16x16x32_bf16 v[28:31], v[128:131], v[172:175], v[28:31]
    v_mfma_f32_16x16x32_bf16 v[48:51], v[128:131], v[176:179], v[48:51]
    ds_read_b128 v[128:131], v4 offset:29696
    s_waitcnt vmcnt(2) lgkmcnt(5)
    v_mfma_f32_16x16x32_bf16 v[12:15], v[92:95], v[180:183], v[12:15]
    v_mfma_f32_16x16x32_bf16 v[32:35], v[92:95], v[184:187], v[32:35]
    ds_read_b128 v[92:95], v5 offset:0
    v_mfma_f32_16x16x32_bf16 v[16:19], v[96:99], v[180:183], v[16:19]
    v_mfma_f32_16x16x32_bf16 v[36:39], v[96:99], v[184:187], v[36:39]
    ds_read_b128 v[96:99], v5 offset:1024
    v_mfma_f32_16x16x32_bf16 v[20:23], v[100:103], v[180:183], v[20:23]
    v_mfma_f32_16x16x32_bf16 v[40:43], v[100:103], v[184:187], v[40:43]
    ds_read_b128 v[100:103], v5 offset:2048
    v_mfma_f32_16x16x32_bf16 v[24:27], v[104:107], v[180:183], v[24:27]
    v_mfma_f32_16x16x32_bf16 v[44:47], v[104:107], v[184:187], v[44:47]
    ds_read_b128 v[104:107], v5 offset:3072
    v_mfma_f32_16x16x32_bf16 v[28:31], v[108:111], v[180:183], v[28:31]
    v_mfma_f32_16x16x32_bf16 v[48:51], v[108:111], v[184:187], v[48:51]
    ds_read_b128 v[108:111], v5 offset:4096
    s_waitcnt vmcnt(0) lgkmcnt(5)
    s_barrier
    v_mfma_f32_16x16x32_bf16 v[12:15], v[112:115], v[188:191], v[12:15]
    v_mfma_f32_16x16x32_bf16 v[32:35], v[112:115], v[192:195], v[32:35]
    ds_read_b128 v[112:115], v5 offset:5120
    v_mfma_f32_16x16x32_bf16 v[16:19], v[116:119], v[188:191], v[16:19]
    v_mfma_f32_16x16x32_bf16 v[36:39], v[116:119], v[192:195], v[36:39]
    ds_read_b128 v[116:119], v5 offset:6144
    v_mfma_f32_16x16x32_bf16 v[20:23], v[120:123], v[188:191], v[20:23]
    v_mfma_f32_16x16x32_bf16 v[40:43], v[120:123], v[192:195], v[40:43]
    ds_read_b128 v[120:123], v5 offset:7168
    v_mfma_f32_16x16x32_bf16 v[24:27], v[124:127], v[188:191], v[24:27]
    v_mfma_f32_16x16x32_bf16 v[44:47], v[124:127], v[192:195], v[44:47]
    ds_read_b128 v[124:127], v5 offset:8192
    v_mfma_f32_16x16x32_bf16 v[28:31], v[128:131], v[188:191], v[28:31]
    v_mfma_f32_16x16x32_bf16 v[48:51], v[128:131], v[192:195], v[48:51]
    ds_read_b128 v[128:131], v5 offset:9216
    buffer_load_dwordx4 v[132:135], v2, s[44:47], s40 offen offset:0 sc1
    ds_write_b128 v7, v[32:35] offset:0
    ds_write_b128 v7, v[36:39] offset:1024
    ds_write_b128 v7, v[40:43] offset:2048
    ds_write_b128 v7, v[44:47] offset:3072
    s_nop 1
    ds_write_b128 v7, v[48:51] offset:4096
    buffer_load_dwordx4 v[136:139], v2, s[44:47], s12 offen offset:0 sc1
    s_waitcnt lgkmcnt(0)
    s_barrier
    ds_read_b128 v[32:35], v254 offset:0
    ds_read_b128 v[36:39], v254 offset:1024
    ds_read_b128 v[40:43], v254 offset:2048
    ds_read_b128 v[44:47], v254 offset:3072
    ds_read_b128 v[48:51], v254 offset:4096
    ds_read_b64 v[232:233], v8 offset:0
    ds_read_b64 v[234:235], v8 offset:32
    ds_read_b64 v[236:237], v8 offset:64
    ds_read_b64 v[238:239], v8 offset:96
    ds_read_b64 v[240:241], v8 offset:128
    buffer_load_dwordx4 v[140:143], v2, s[44:47], s40 offen offset:1024 sc1
    s_waitcnt lgkmcnt(5)
    v_pk_add_f32 v[32:33], v[32:33], v[12:13] op_sel:[0,0] op_sel_hi:[1,1]
    v_pk_add_f32 v[34:35], v[34:35], v[14:15] op_sel:[0,0] op_sel_hi:[1,1]
    v_pk_add_f32 v[36:37], v[36:37], v[16:17] op_sel:[0,0] op_sel_hi:[1,1]
    v_pk_add_f32 v[38:39], v[38:39], v[18:19] op_sel:[0,0] op_sel_hi:[1,1]
    v_pk_add_f32 v[40:41], v[40:41], v[20:21] op_sel:[0,0] op_sel_hi:[1,1]
    v_pk_add_f32 v[42:43], v[42:43], v[22:23] op_sel:[0,0] op_sel_hi:[1,1]
    v_pk_add_f32 v[44:45], v[44:45], v[24:25] op_sel:[0,0] op_sel_hi:[1,1]
    v_pk_add_f32 v[46:47], v[46:47], v[26:27] op_sel:[0,0] op_sel_hi:[1,1]
    buffer_load_dwordx4 v[144:147], v2, s[44:47], s12 offen offset:1024 sc1
    v_pk_add_f32 v[48:49], v[48:49], v[28:29] op_sel:[0,0] op_sel_hi:[1,1]
    v_pk_add_f32 v[50:51], v[50:51], v[30:31] op_sel:[0,0] op_sel_hi:[1,1]
    v_pk_mul_f32 v[212:213], v[32:33], v[10:11] op_sel:[0,0] op_sel_hi:[1,0]
    v_pk_mul_f32 v[214:215], v[34:35], v[10:11] op_sel:[0,0] op_sel_hi:[1,0]
    v_pk_mul_f32 v[216:217], v[36:37], v[10:11] op_sel:[0,0] op_sel_hi:[1,0]
    v_pk_mul_f32 v[218:219], v[38:39], v[10:11] op_sel:[0,0] op_sel_hi:[1,0]
    v_pk_mul_f32 v[220:221], v[40:41], v[10:11] op_sel:[0,0] op_sel_hi:[1,0]
    buffer_load_dwordx4 v[148:151], v2, s[44:47], s41 offen offset:0 sc1
    v_pk_mul_f32 v[222:223], v[42:43], v[10:11] op_sel:[0,0] op_sel_hi:[1,0]
    v_pk_mul_f32 v[224:225], v[44:45], v[10:11] op_sel:[0,0] op_sel_hi:[1,0]
    v_pk_mul_f32 v[226:227], v[46:47], v[10:11] op_sel:[0,0] op_sel_hi:[1,0]
    v_pk_mul_f32 v[228:229], v[48:49], v[10:11] op_sel:[0,0] op_sel_hi:[1,0]
    v_pk_mul_f32 v[230:231], v[50:51], v[10:11] op_sel:[0,0] op_sel_hi:[1,0]
    v_exp_f32 v212, v212
    v_exp_f32 v213, v213
    buffer_load_dwordx4 v[152:155], v2, s[44:47], s13 offen offset:0 sc1
    v_exp_f32 v214, v214
    v_exp_f32 v215, v215
    v_exp_f32 v216, v216
    v_exp_f32 v217, v217
    v_exp_f32 v218, v218
    v_exp_f32 v219, v219
    v_exp_f32 v220, v220
    v_exp_f32 v221, v221
    buffer_load_dwordx4 v[156:159], v2, s[44:47], s41 offen offset:1024 sc1
    v_exp_f32 v222, v222
    v_exp_f32 v223, v223
    v_exp_f32 v224, v224
    v_exp_f32 v225, v225
    v_exp_f32 v226, v226
    v_exp_f32 v227, v227
    v_exp_f32 v228, v228
    buffer_load_dwordx4 v[160:163], v2, s[44:47], s13 offen offset:1024 sc1
    v_exp_f32 v229, v229
    v_exp_f32 v230, v230
    v_exp_f32 v231, v231
    v_pk_add_f32 v[212:213], v[212:213], 1.0 op_sel:[0,0] op_sel_hi:[1,0]
    v_pk_add_f32 v[214:215], v[214:215], 1.0 op_sel:[0,0] op_sel_hi:[1,0]
    v_pk_add_f32 v[216:217], v[216:217], 1.0 op_sel:[0,0] op_sel_hi:[1,0]
    v_pk_add_f32 v[218:219], v[218:219], 1.0 op_sel:[0,0] op_sel_hi:[1,0]
    buffer_load_dwordx2 v[164:165], v3, s[44:47], s40 offen offset:2048 sc1
    v_pk_add_f32 v[220:221], v[220:221], 1.0 op_sel:[0,0] op_sel_hi:[1,0]
    v_pk_add_f32 v[222:223], v[222:223], 1.0 op_sel:[0,0] op_sel_hi:[1,0]
    v_pk_add_f32 v[224:225], v[224:225], 1.0 op_sel:[0,0] op_sel_hi:[1,0]
    v_pk_add_f32 v[226:227], v[226:227], 1.0 op_sel:[0,0] op_sel_hi:[1,0]
    v_pk_add_f32 v[228:229], v[228:229], 1.0 op_sel:[0,0] op_sel_hi:[1,0]
    v_pk_add_f32 v[230:231], v[230:231], 1.0 op_sel:[0,0] op_sel_hi:[1,0]
    v_rcp_f32 v212, v212
    buffer_load_dwordx2 v[166:167], v3, s[44:47], s41 offen offset:2048 sc1
    v_rcp_f32 v213, v213
    v_rcp_f32 v214, v214
    v_rcp_f32 v215, v215
    v_rcp_f32 v216, v216
    v_rcp_f32 v217, v217
    v_rcp_f32 v218, v218
    v_rcp_f32 v219, v219
    v_rcp_f32 v220, v220
    buffer_load_dwordx2 v[168:169], v3, s[44:47], s12 offen offset:2048 sc1
    v_rcp_f32 v221, v221
    v_rcp_f32 v222, v222
    v_rcp_f32 v223, v223
    v_rcp_f32 v224, v224
    v_rcp_f32 v225, v225
    v_rcp_f32 v226, v226
    v_rcp_f32 v227, v227
    buffer_load_dwordx2 v[170:171], v3, s[44:47], s13 offen offset:2048 sc1
    v_rcp_f32 v228, v228
    v_rcp_f32 v229, v229
    v_rcp_f32 v230, v230
    v_rcp_f32 v231, v231
    v_pk_mul_f32 v[32:33], v[32:33], v[212:213] op_sel:[0,0] op_sel_hi:[1,1]
    v_pk_mul_f32 v[34:35], v[34:35], v[214:215] op_sel:[0,0] op_sel_hi:[1,1]
    v_pk_mul_f32 v[36:37], v[36:37], v[216:217] op_sel:[0,0] op_sel_hi:[1,1]
    buffer_load_dwordx4 v[172:175], v2, s[44:47], s42 offen offset:0 sc1
    v_pk_mul_f32 v[38:39], v[38:39], v[218:219] op_sel:[0,0] op_sel_hi:[1,1]
    v_pk_mul_f32 v[40:41], v[40:41], v[220:221] op_sel:[0,0] op_sel_hi:[1,1]
    v_pk_mul_f32 v[42:43], v[42:43], v[222:223] op_sel:[0,0] op_sel_hi:[1,1]
    v_pk_mul_f32 v[44:45], v[44:45], v[224:225] op_sel:[0,0] op_sel_hi:[1,1]
    v_pk_mul_f32 v[46:47], v[46:47], v[226:227] op_sel:[0,0] op_sel_hi:[1,1]
    v_pk_mul_f32 v[48:49], v[48:49], v[228:229] op_sel:[0,0] op_sel_hi:[1,1]
    v_pk_mul_f32 v[50:51], v[50:51], v[230:231] op_sel:[0,0] op_sel_hi:[1,1]
    buffer_load_dwordx4 v[176:179], v2, s[44:47], s14 offen offset:0 sc1
    s_waitcnt lgkmcnt(0)
    s_waitcnt vmcnt(12)
    v_mfma_f32_16x16x32_bf16 v[52:55], v[92:95], v[132:135], 0
    buffer_load_dwordx4 v[180:183], v2, s[44:47], s42 offen offset:1024 sc1
    v_lshlrev_b32 v12, 16, v232
    v_mfma_f32_16x16x32_bf16 v[72:75], v[92:95], v[136:139], 0
    ds_read_b128 v[92:95], v5 offset:20480
    v_and_b32 v13, v255, v232
    v_mfma_f32_16x16x32_bf16 v[56:59], v[96:99], v[132:135], 0
    v_lshlrev_b32 v14, 16, v233
    v_mfma_f32_16x16x32_bf16 v[76:79], v[96:99], v[136:139], 0
    ds_read_b128 v[96:99], v5 offset:21504
    v_and_b32 v15, v255, v233
    v_mfma_f32_16x16x32_bf16 v[60:63], v[100:103], v[132:135], 0
    v_lshlrev_b32 v16, 16, v234
    v_mfma_f32_16x16x32_bf16 v[80:83], v[100:103], v[136:139], 0
    ds_read_b128 v[100:103], v5 offset:22528
    buffer_load_dwordx4 v[184:187], v2, s[44:47], s14 offen offset:1024 sc1
    v_and_b32 v17, v255, v234
    v_mfma_f32_16x16x32_bf16 v[64:67], v[104:107], v[132:135], 0
    v_lshlrev_b32 v18, 16, v235
    v_mfma_f32_16x16x32_bf16 v[84:87], v[104:107], v[136:139], 0
    ds_read_b128 v[104:107], v5 offset:23552
    v_and_b32 v19, v255, v235
    v_mfma_f32_16x16x32_bf16 v[68:71], v[108:111], v[132:135], 0
    v_lshlrev_b32 v20, 16, v236
    v_mfma_f32_16x16x32_bf16 v[88:91], v[108:111], v[136:139], 0
    ds_read_b128 v[108:111], v5 offset:24576
    v_and_b32 v21, v255, v236
    s_waitcnt vmcnt(12)
    v_mfma_f32_16x16x32_bf16 v[52:55], v[112:115], v[140:143], v[52:55]
    buffer_load_dwordx4 v[188:191], v2, s[44:47], s43 offen offset:0 sc1
    v_lshlrev_b32 v22, 16, v237
    v_mfma_f32_16x16x32_bf16 v[72:75], v[112:115], v[144:147], v[72:75]
    ds_read_b128 v[112:115], v5 offset:25600
    v_and_b32 v23, v255, v237
    v_mfma_f32_16x16x32_bf16 v[56:59], v[116:119], v[140:143], v[56:59]
    v_lshlrev_b32 v24, 16, v238
    v_mfma_f32_16x16x32_bf16 v[76:79], v[116:119], v[144:147], v[76:79]
    ds_read_b128 v[116:119], v5 offset:26624
    v_and_b32 v25, v255, v238
    v_mfma_f32_16x16x32_bf16 v[60:63], v[120:123], v[140:143], v[60:63]
    v_lshlrev_b32 v26, 16, v239
    v_mfma_f32_16x16x32_bf16 v[80:83], v[120:123], v[144:147], v[80:83]
    ds_read_b128 v[120:123], v5 offset:27648
    buffer_load_dwordx4 v[192:195], v2, s[44:47], s15 offen offset:0 sc1
    v_and_b32 v27, v255, v239
    v_mfma_f32_16x16x32_bf16 v[64:67], v[124:127], v[140:143], v[64:67]
    v_lshlrev_b32 v28, 16, v240
    v_mfma_f32_16x16x32_bf16 v[84:87], v[124:127], v[144:147], v[84:87]
    ds_read_b128 v[124:127], v5 offset:28672
    v_and_b32 v29, v255, v240
    v_mfma_f32_16x16x32_bf16 v[68:71], v[128:131], v[140:143], v[68:71]
    v_lshlrev_b32 v30, 16, v241
    v_mfma_f32_16x16x32_bf16 v[88:91], v[128:131], v[144:147], v[88:91]
    ds_read_b128 v[128:131], v5 offset:29696
    v_and_b32 v31, v255, v241
    s_waitcnt vmcnt(12) lgkmcnt(5)
    v_mfma_f32_16x16x32_bf16 v[52:55], v[92:95], v[148:151], v[52:55]
    buffer_load_dwordx4 v[196:199], v2, s[44:47], s43 offen offset:1024 sc1
    v_mfma_f32_16x16x32_bf16 v[72:75], v[92:95], v[152:155], v[72:75]
    ds_read_b128 v[92:95], v6 offset:0
    v_mfma_f32_16x16x32_bf16 v[56:59], v[96:99], v[148:151], v[56:59]
    v_mfma_f32_16x16x32_bf16 v[76:79], v[96:99], v[152:155], v[76:79]
    ds_read_b128 v[96:99], v6 offset:1024
    v_mfma_f32_16x16x32_bf16 v[60:63], v[100:103], v[148:151], v[60:63]
    v_mfma_f32_16x16x32_bf16 v[80:83], v[100:103], v[152:155], v[80:83]
    ds_read_b128 v[100:103], v6 offset:2048
    buffer_load_dwordx4 v[200:203], v2, s[44:47], s15 offen offset:1024 sc1
    v_mfma_f32_16x16x32_bf16 v[64:67], v[104:107], v[148:151], v[64:67]
    v_mfma_f32_16x16x32_bf16 v[84:87], v[104:107], v[152:155], v[84:87]
    ds_read_b128 v[104:107], v6 offset:3072
    v_mfma_f32_16x16x32_bf16 v[68:71], v[108:111], v[148:151], v[68:71]
    v_mfma_f32_16x16x32_bf16 v[88:91], v[108:111], v[152:155], v[88:91]
    ds_read_b128 v[108:111], v6 offset:4096
    s_waitcnt vmcnt(12) lgkmcnt(5)
    v_mfma_f32_16x16x32_bf16 v[52:55], v[112:115], v[156:159], v[52:55]
    buffer_load_dwordx2 v[204:205], v3, s[44:47], s42 offen offset:2048 sc1
    v_mfma_f32_16x16x32_bf16 v[72:75], v[112:115], v[160:163], v[72:75]
    ds_read_b128 v[112:115], v6 offset:5120
    v_mfma_f32_16x16x32_bf16 v[56:59], v[116:119], v[156:159], v[56:59]
    v_mfma_f32_16x16x32_bf16 v[76:79], v[116:119], v[160:163], v[76:79]
    ds_read_b128 v[116:119], v6 offset:6144
    v_mfma_f32_16x16x32_bf16 v[60:63], v[120:123], v[156:159], v[60:63]
    v_mfma_f32_16x16x32_bf16 v[80:83], v[120:123], v[160:163], v[80:83]
    ds_read_b128 v[120:123], v6 offset:7168
    buffer_load_dwordx2 v[206:207], v3, s[44:47], s43 offen offset:2048 sc1
    v_mfma_f32_16x16x32_bf16 v[64:67], v[124:127], v[156:159], v[64:67]
    v_mfma_f32_16x16x32_bf16 v[84:87], v[124:127], v[160:163], v[84:87]
    ds_read_b128 v[124:127], v6 offset:8192
    v_mfma_f32_16x16x32_bf16 v[68:71], v[128:131], v[156:159], v[68:71]
    v_mfma_f32_16x16x32_bf16 v[88:91], v[128:131], v[160:163], v[88:91]
    ds_read_b128 v[128:131], v6 offset:9216
    s_waitcnt vmcnt(10) lgkmcnt(5)
    v_mfma_f32_16x16x32_bf16 v[52:55], v[92:95], v[164:167], v[52:55]
    buffer_load_dwordx2 v[208:209], v3, s[44:47], s14 offen offset:2048 sc1
    v_mfma_f32_16x16x32_bf16 v[72:75], v[92:95], v[168:171], v[72:75]
    ds_read_b128 v[92:95], v6 offset:20480
    v_mfma_f32_16x16x32_bf16 v[56:59], v[96:99], v[164:167], v[56:59]
    v_mfma_f32_16x16x32_bf16 v[76:79], v[96:99], v[168:171], v[76:79]
    ds_read_b128 v[96:99], v6 offset:21504
    v_mfma_f32_16x16x32_bf16 v[60:63], v[100:103], v[164:167], v[60:63]
    v_mfma_f32_16x16x32_bf16 v[80:83], v[100:103], v[168:171], v[80:83]
    ds_read_b128 v[100:103], v6 offset:22528
    buffer_load_dwordx2 v[210:211], v3, s[44:47], s15 offen offset:2048 sc1
    v_mfma_f32_16x16x32_bf16 v[64:67], v[104:107], v[164:167], v[64:67]
    v_mfma_f32_16x16x32_bf16 v[84:87], v[104:107], v[168:171], v[84:87]
    ds_read_b128 v[104:107], v6 offset:23552
    v_mfma_f32_16x16x32_bf16 v[68:71], v[108:111], v[164:167], v[68:71]
    v_mfma_f32_16x16x32_bf16 v[88:91], v[108:111], v[168:171], v[88:91]
    ds_read_b128 v[108:111], v6 offset:24576
    s_waitcnt vmcnt(10) lgkmcnt(5)
    v_mfma_f32_16x16x32_bf16 v[52:55], v[112:115], v[172:175], v[52:55]
    v_mfma_f32_16x16x32_bf16 v[72:75], v[112:115], v[176:179], v[72:75]
    ds_read_b128 v[112:115], v6 offset:25600
    v_mfma_f32_16x16x32_bf16 v[56:59], v[116:119], v[172:175], v[56:59]
    v_mfma_f32_16x16x32_bf16 v[76:79], v[116:119], v[176:179], v[76:79]
    ds_read_b128 v[116:119], v6 offset:26624
    v_mfma_f32_16x16x32_bf16 v[60:63], v[120:123], v[172:175], v[60:63]
    v_mfma_f32_16x16x32_bf16 v[80:83], v[120:123], v[176:179], v[80:83]
    ds_read_b128 v[120:123], v6 offset:27648
    v_mfma_f32_16x16x32_bf16 v[64:67], v[124:127], v[172:175], v[64:67]
    v_mfma_f32_16x16x32_bf16 v[84:87], v[124:127], v[176:179], v[84:87]
    ds_read_b128 v[124:127], v6 offset:28672
    v_mfma_f32_16x16x32_bf16 v[68:71], v[128:131], v[172:175], v[68:71]
    v_mfma_f32_16x16x32_bf16 v[88:91], v[128:131], v[176:179], v[88:91]
    ds_read_b128 v[128:131], v6 offset:29696
    s_waitcnt vmcnt(8) lgkmcnt(5)
    v_mfma_f32_16x16x32_bf16 v[52:55], v[92:95], v[180:183], v[52:55]
    v_mfma_f32_16x16x32_bf16 v[72:75], v[92:95], v[184:187], v[72:75]
    ds_read_b128 v[92:95], v4 offset:0
    v_mfma_f32_16x16x32_bf16 v[56:59], v[96:99], v[180:183], v[56:59]
    v_mfma_f32_16x16x32_bf16 v[76:79], v[96:99], v[184:187], v[76:79]
    ds_read_b128 v[96:99], v4 offset:1024
    v_mfma_f32_16x16x32_bf16 v[60:63], v[100:103], v[180:183], v[60:63]
    v_mfma_f32_16x16x32_bf16 v[80:83], v[100:103], v[184:187], v[80:83]
    ds_read_b128 v[100:103], v4 offset:2048
    v_mfma_f32_16x16x32_bf16 v[64:67], v[104:107], v[180:183], v[64:67]
    v_mfma_f32_16x16x32_bf16 v[84:87], v[104:107], v[184:187], v[84:87]
    ds_read_b128 v[104:107], v4 offset:3072
    v_mfma_f32_16x16x32_bf16 v[68:71], v[108:111], v[180:183], v[68:71]
    v_mfma_f32_16x16x32_bf16 v[88:91], v[108:111], v[184:187], v[88:91]
    ds_read_b128 v[108:111], v4 offset:4096
    s_waitcnt vmcnt(6) lgkmcnt(5)
    v_mfma_f32_16x16x32_bf16 v[52:55], v[112:115], v[188:191], v[52:55]
    v_mfma_f32_16x16x32_bf16 v[72:75], v[112:115], v[192:195], v[72:75]
    ds_read_b128 v[112:115], v4 offset:5120
    v_mfma_f32_16x16x32_bf16 v[56:59], v[116:119], v[188:191], v[56:59]
    v_mfma_f32_16x16x32_bf16 v[76:79], v[116:119], v[192:195], v[76:79]
    ds_read_b128 v[116:119], v4 offset:6144
    v_mfma_f32_16x16x32_bf16 v[60:63], v[120:123], v[188:191], v[60:63]
    v_mfma_f32_16x16x32_bf16 v[80:83], v[120:123], v[192:195], v[80:83]
    ds_read_b128 v[120:123], v4 offset:7168
    v_mfma_f32_16x16x32_bf16 v[64:67], v[124:127], v[188:191], v[64:67]
    v_mfma_f32_16x16x32_bf16 v[84:87], v[124:127], v[192:195], v[84:87]
    ds_read_b128 v[124:127], v4 offset:8192
    v_mfma_f32_16x16x32_bf16 v[68:71], v[128:131], v[188:191], v[68:71]
    v_mfma_f32_16x16x32_bf16 v[88:91], v[128:131], v[192:195], v[88:91]
    ds_read_b128 v[128:131], v4 offset:9216
    s_waitcnt vmcnt(4) lgkmcnt(5)
    v_mfma_f32_16x16x32_bf16 v[52:55], v[92:95], v[196:199], v[52:55]
    v_mfma_f32_16x16x32_bf16 v[72:75], v[92:95], v[200:203], v[72:75]
    v_mfma_f32_16x16x32_bf16 v[56:59], v[96:99], v[196:199], v[56:59]
    v_mfma_f32_16x16x32_bf16 v[76:79], v[96:99], v[200:203], v[76:79]
    v_mfma_f32_16x16x32_bf16 v[60:63], v[100:103], v[196:199], v[60:63]
    v_mfma_f32_16x16x32_bf16 v[80:83], v[100:103], v[200:203], v[80:83]
    v_mfma_f32_16x16x32_bf16 v[64:67], v[104:107], v[196:199], v[64:67]
    v_mfma_f32_16x16x32_bf16 v[84:87], v[104:107], v[200:203], v[84:87]
    v_mfma_f32_16x16x32_bf16 v[68:71], v[108:111], v[196:199], v[68:71]
    v_mfma_f32_16x16x32_bf16 v[88:91], v[108:111], v[200:203], v[88:91]
    s_waitcnt vmcnt(0) lgkmcnt(0)
    v_mfma_f32_16x16x32_bf16 v[72:75], v[112:115], v[208:211], v[72:75]
    v_mfma_f32_16x16x32_bf16 v[76:79], v[116:119], v[208:211], v[76:79]
    v_mfma_f32_16x16x32_bf16 v[80:83], v[120:123], v[208:211], v[80:83]
    v_mfma_f32_16x16x32_bf16 v[84:87], v[124:127], v[208:211], v[84:87]
    v_mfma_f32_16x16x32_bf16 v[88:91], v[128:131], v[208:211], v[88:91]
    v_mfma_f32_16x16x32_bf16 v[52:55], v[112:115], v[204:207], v[52:55]
    v_mfma_f32_16x16x32_bf16 v[56:59], v[116:119], v[204:207], v[56:59]
    v_mfma_f32_16x16x32_bf16 v[60:63], v[120:123], v[204:207], v[60:63]
    v_mfma_f32_16x16x32_bf16 v[64:67], v[124:127], v[204:207], v[64:67]
    v_mfma_f32_16x16x32_bf16 v[68:71], v[128:131], v[204:207], v[68:71]
    ds_write_b128 v7, v[72:75] offset:0
    ds_write_b128 v7, v[76:79] offset:1024
    ds_write_b128 v7, v[80:83] offset:2048
    ds_write_b128 v7, v[84:87] offset:3072
    ds_write_b128 v7, v[88:91] offset:4096
    s_waitcnt lgkmcnt(0)
    s_barrier
    ds_read_b128 v[92:95], v254 offset:0
    ds_read_b128 v[96:99], v254 offset:1024
    ds_read_b128 v[100:103], v254 offset:2048
    ds_read_b128 v[104:107], v254 offset:3072
    ds_read_b128 v[108:111], v254 offset:4096
    s_waitcnt lgkmcnt(4)
    v_pk_add_f32 v[92:93], v[92:93], v[52:53] op_sel:[0,0] op_sel_hi:[1,1]
    v_pk_add_f32 v[94:95], v[94:95], v[54:55] op_sel:[0,0] op_sel_hi:[1,1]
    v_pk_fma_f32 v[12:13], v[92:93], v[32:33], v[12:13] op_sel:[0,0,0] op_sel_hi:[1,1,1]
    v_pk_fma_f32 v[14:15], v[94:95], v[34:35], v[14:15] op_sel:[0,0,0] op_sel_hi:[1,1,1]
    v_cvt_pk_bf16_f32 v12, v12, v13
    v_cvt_pk_bf16_f32 v13, v14, v15
    ds_write_b64 v9, v[12:13] offset:0
    s_waitcnt lgkmcnt(4)
    v_pk_add_f32 v[96:97], v[96:97], v[56:57] op_sel:[0,0] op_sel_hi:[1,1]
    v_pk_add_f32 v[98:99], v[98:99], v[58:59] op_sel:[0,0] op_sel_hi:[1,1]
    v_pk_fma_f32 v[16:17], v[96:97], v[36:37], v[16:17] op_sel:[0,0,0] op_sel_hi:[1,1,1]
    v_pk_fma_f32 v[18:19], v[98:99], v[38:39], v[18:19] op_sel:[0,0,0] op_sel_hi:[1,1,1]
    v_cvt_pk_bf16_f32 v16, v16, v17
    v_cvt_pk_bf16_f32 v17, v18, v19
    ds_write_b64 v9, v[16:17] offset:32
    s_waitcnt lgkmcnt(4)
    v_pk_add_f32 v[100:101], v[100:101], v[60:61] op_sel:[0,0] op_sel_hi:[1,1]
    v_pk_add_f32 v[102:103], v[102:103], v[62:63] op_sel:[0,0] op_sel_hi:[1,1]
    v_pk_fma_f32 v[20:21], v[100:101], v[40:41], v[20:21] op_sel:[0,0,0] op_sel_hi:[1,1,1]
    v_pk_fma_f32 v[22:23], v[102:103], v[42:43], v[22:23] op_sel:[0,0,0] op_sel_hi:[1,1,1]
    v_cvt_pk_bf16_f32 v20, v20, v21
    v_cvt_pk_bf16_f32 v21, v22, v23
    ds_write_b64 v9, v[20:21] offset:64
    s_waitcnt lgkmcnt(4)
    v_pk_add_f32 v[104:105], v[104:105], v[64:65] op_sel:[0,0] op_sel_hi:[1,1]
    v_pk_add_f32 v[106:107], v[106:107], v[66:67] op_sel:[0,0] op_sel_hi:[1,1]
    v_pk_fma_f32 v[24:25], v[104:105], v[44:45], v[24:25] op_sel:[0,0,0] op_sel_hi:[1,1,1]
    v_pk_fma_f32 v[26:27], v[106:107], v[46:47], v[26:27] op_sel:[0,0,0] op_sel_hi:[1,1,1]
    v_cvt_pk_bf16_f32 v24, v24, v25
    v_cvt_pk_bf16_f32 v25, v26, v27
    ds_write_b64 v9, v[24:25] offset:96
    s_waitcnt lgkmcnt(4)
    v_pk_add_f32 v[108:109], v[108:109], v[68:69] op_sel:[0,0] op_sel_hi:[1,1]
    v_pk_add_f32 v[110:111], v[110:111], v[70:71] op_sel:[0,0] op_sel_hi:[1,1]
    v_pk_fma_f32 v[28:29], v[108:109], v[48:49], v[28:29] op_sel:[0,0,0] op_sel_hi:[1,1,1]
    v_pk_fma_f32 v[30:31], v[110:111], v[50:51], v[30:31] op_sel:[0,0,0] op_sel_hi:[1,1,1]
    v_cvt_pk_bf16_f32 v28, v28, v29
    v_cvt_pk_bf16_f32 v29, v30, v31
    ds_write_b64 v9, v[28:29] offset:128
    s_waitcnt lgkmcnt(0)
    s_barrier
Lfinal_store:
    ds_read_b64 v[4:5], v248
    ds_read_b64 v[6:7], v248 offset:8
    s_waitcnt lgkmcnt(0)
    buffer_store_dwordx4 v[4:7], v249, s[52:55], s83 offen
Lfin:
Lend:
    s_endpgm
Lok:
    s_waitcnt vmcnt(12) lgkmcnt(5)
    s_barrier
    v_mfma_f32_16x16x32_bf16 v[12:15], v[112:115], v[172:175], v[12:15]
    buffer_load_dwordx4 v[164:167], v250, s[44:47], s34 offen offset:0 sc1
    v_mfma_f32_16x16x32_bf16 v[32:35], v[112:115], v[176:179], v[32:35]
    ds_read_b128 v[112:115], v6 offset:25600
    v_mfma_f32_16x16x32_bf16 v[16:19], v[116:119], v[172:175], v[16:19]
    v_mfma_f32_16x16x32_bf16 v[36:39], v[116:119], v[176:179], v[36:39]
    ds_read_b128 v[116:119], v6 offset:26624
    v_mfma_f32_16x16x32_bf16 v[20:23], v[120:123], v[172:175], v[20:23]
    v_mfma_f32_16x16x32_bf16 v[40:43], v[120:123], v[176:179], v[40:43]
    ds_read_b128 v[120:123], v6 offset:27648
    buffer_load_dwordx4 v[168:171], v251, s[44:47], s34 offen offset:0 sc1
    v_mfma_f32_16x16x32_bf16 v[24:27], v[124:127], v[172:175], v[24:27]
    v_mfma_f32_16x16x32_bf16 v[44:47], v[124:127], v[176:179], v[44:47]
    ds_read_b128 v[124:127], v6 offset:28672
    v_mfma_f32_16x16x32_bf16 v[28:31], v[128:131], v[172:175], v[28:31]
    v_mfma_f32_16x16x32_bf16 v[48:51], v[128:131], v[176:179], v[48:51]
    ds_read_b128 v[128:131], v6 offset:29696
    s_waitcnt vmcnt(12) lgkmcnt(5)
    v_mfma_f32_16x16x32_bf16 v[12:15], v[92:95], v[180:183], v[12:15]
    buffer_load_dwordx4 v[172:175], v250, s[44:47], s34 offen offset:1024 sc1
    v_mfma_f32_16x16x32_bf16 v[32:35], v[92:95], v[184:187], v[32:35]
    ds_read_b128 v[92:95], v4 offset:0
    v_mfma_f32_16x16x32_bf16 v[16:19], v[96:99], v[180:183], v[16:19]
    v_mfma_f32_16x16x32_bf16 v[36:39], v[96:99], v[184:187], v[36:39]
    ds_read_b128 v[96:99], v4 offset:1024
    v_mfma_f32_16x16x32_bf16 v[20:23], v[100:103], v[180:183], v[20:23]
    v_mfma_f32_16x16x32_bf16 v[40:43], v[100:103], v[184:187], v[40:43]
    ds_read_b128 v[100:103], v4 offset:2048
    buffer_load_dwordx4 v[176:179], v251, s[44:47], s34 offen offset:1024 sc1
    v_mfma_f32_16x16x32_bf16 v[24:27], v[104:107], v[180:183], v[24:27]
    v_mfma_f32_16x16x32_bf16 v[44:47], v[104:107], v[184:187], v[44:47]
    ds_read_b128 v[104:107], v4 offset:3072
    v_mfma_f32_16x16x32_bf16 v[28:31], v[108:111], v[180:183], v[28:31]
    v_mfma_f32_16x16x32_bf16 v[48:51], v[108:111], v[184:187], v[48:51]
    ds_read_b128 v[108:111], v4 offset:4096
    s_branch Loj
Lcode_end:
.section .rodata,"a"
.p2align 6
.amdhsa_kernel recurrent_scan__linear_attn_block__mixer_channel_mlp__prompt_kernel
  .amdhsa_next_free_vgpr 256
  .amdhsa_next_free_sgpr 102
  .amdhsa_accum_offset 256
  .amdhsa_group_segment_fixed_size 0
  .amdhsa_kernarg_size 88
  .amdhsa_user_sgpr_count 2
  .amdhsa_user_sgpr_kernarg_segment_ptr 1
  .amdhsa_system_sgpr_workgroup_id_x 1
.end_amdhsa_kernel
```
